```python
import torch

def _softmax(x, axis=-1):
    return torch.softmax(x, dim=axis)

def _gelu(x):
    return torch.nn.functional.gelu(x, approximate='tanh')

def _silu(x):
    return torch.nn.functional.silu(x)

def _sigmoid(x):
    return torch.sigmoid(x)

def _layernorm(x, axis=-1, eps=1e-05):
    m = x.mean(dim=axis, keepdim=True)
    v = x.var(dim=axis, keepdim=True, unbiased=False)
    return (x - m) / torch.sqrt(v + eps)

def _scatter_add(tgt, idx, src, axis=0):
    return tgt.clone().index_add_(axis, idx, src)

def _segment_sum(src, seg, n):
    out = torch.zeros((n,) + src.shape[1:], dtype=src.dtype)
    return out.index_add_(0, seg, src)

def _pad(x, pw):
    flat = tuple((v for pair in reversed(pw) for v in pair))
    return torch.nn.functional.pad(x, flat)
kernel_name = 'adaLN_cond__ssm_conv_s4__glu_gated_bilinear__prompt'

def setup_inputs():

    _w = lambda a: (lambda t: t.to(torch.bfloat16) if t.is_floating_point() else t)(torch.as_tensor(a))

    def _A_setup():
        B, L, D, N = (1, 2048, 448, 256)
        A_re = -(lambda _x: torch.exp(torch.as_tensor(_x)))((lambda *s: torch.randn(*s, dtype=torch.bfloat16) * 3.2)(D, N))
        A_im = torch.pi * (lambda *s: torch.randn(*s, dtype=torch.bfloat16) * 0.1)(D, N)
        B_re = (lambda *s: torch.randn(*s, dtype=torch.bfloat16) * 0.1)(D, N)
        B_im = (lambda *s: torch.randn(*s, dtype=torch.bfloat16) * 0.1)(D, N)
        C_re = (lambda *s: torch.randn(*s, dtype=torch.bfloat16) * 0.1)(D, N)
        C_im = (lambda *s: torch.randn(*s, dtype=torch.bfloat16) * 0.1)(D, N)
        log_dt = (lambda *s: torch.randn(*s, dtype=torch.bfloat16) * 0.1)(D) * 0.5 - 4.0
        Dskip = (lambda *s: torch.randn(*s, dtype=torch.bfloat16) * 0.1)(D)
        return {'u': _w((lambda *s: torch.randn(*s, dtype=torch.bfloat16) * 0.05)(B, L, D)), 'A_re': _w(A_re), 'A_im': _w(A_im), 'B_re': _w(B_re), 'B_im': _w(B_im), 'C_re': _w(C_re), 'C_im': _w(C_im), 'log_dt': _w(log_dt), 'Dskip': _w(Dskip)}
    _A_in = _A_setup()

    def _B_setup():
        B, S, D, F = (1, 2048, 448, 1792)
        return {'x': _w((lambda *s: torch.randn(*s, dtype=torch.bfloat16) * 0.05)(B, S, D)), 'w_gate': _w((lambda *s: torch.randn(*s, dtype=torch.bfloat16) * 1.6)(D, F) * D ** (-0.5)), 'w_up': _w((lambda *s: torch.randn(*s, dtype=torch.bfloat16) * 1.6)(D, F) * D ** (-0.5)), 'w_down': _w((lambda *s: torch.randn(*s, dtype=torch.bfloat16) * 1.6)(F, D) * F ** (-0.5))}
    _B_in = _B_setup()
    return {'A_u': _A_in['u'], 'A_A_re': _A_in['A_re'], 'A_A_im': _A_in['A_im'], 'A_B_re': _A_in['B_re'], 'A_B_im': _A_in['B_im'], 'A_C_re': _A_in['C_re'], 'A_C_im': _A_in['C_im'], 'A_log_dt': _A_in['log_dt'], 'A_Dskip': _A_in['Dskip'], 'B_x': _B_in['x'], 'B_w_gate': _B_in['w_gate'], 'B_w_up': _B_in['w_up'], 'B_w_down': _B_in['w_down'], 'c': _w((lambda *s: torch.randn(*s, dtype=torch.bfloat16) * 0.2)(1, 448) * 8.0), 'w_mod': _w((lambda *s: torch.randn(*s, dtype=torch.bfloat16) * 0.2)(448, 6 * 448) * 448 ** (-0.5) * 8.0)}

def reference(A_u, A_A_re, A_A_im, A_B_re, A_B_im, A_C_re, A_C_im, A_log_dt, A_Dskip, B_x, B_w_gate, B_w_up, B_w_down, c, w_mod):

    def _A_ref(u, A_re, A_im, B_re, B_im, C_re, C_im, log_dt, Dskip):
        Bsz, L, D = u.shape
        dt = torch.exp(log_dt)[:, None]
        A = A_re + 1j * A_im
        Bc = B_re + 1j * B_im
        Cc = C_re + 1j * C_im
        logdA = dt * A
        dB = dt * Bc
        l = (lambda x, dt: x.to(dt))(torch.arange(L), A_re.dtype)
        P = torch.exp(logdA[:, :, None] * l[None, None, :])
        K = torch.einsum('dn,dnl,dn->dl', Cc, P, dB).real
        L2 = 2 * L
        Kp = _pad(K, ((0, 0), (0, L)))
        up = (lambda x, *d: x.permute(*d))(u, 0, 2, 1)
        up = _pad(up, ((0, 0), (0, 0), (0, L)))
        Kf = (lambda x, axes=(-2, -1): torch.fft.rfft2(x.float(), dim=axes))(Kp[:, None, :], axes=(-2, -1))
        Uf = (lambda x, axes=(-2, -1): torch.fft.rfft2(x.float(), dim=axes))(up[:, :, None, :], axes=(-2, -1))
        Yf = Uf * Kf[None, :, :, :]
        y = (lambda x, s, axes=(-2, -1): torch.fft.irfft2(x, s=s, dim=axes).to(torch.bfloat16))(Yf, (1, L2), axes=(-2, -1))[:, :, 0, :L]
        y = (lambda x, *d: x.permute(*d))(y, 0, 2, 1) + u * Dskip[None, None, :]
        return y

    def _B_ref(x, w_gate, w_up, w_down):
        g = torch.einsum('bsd,df->bsf', x, w_gate)
        u = torch.einsum('bsd,df->bsf', x, w_up)
        h = g * u
        return torch.einsum('bsf,fd->bsd', h, w_down)
    x = A_u
    mod = (_silu(c) @ w_mod).reshape(c.shape[0], 6, 1, -1)
    sa, ca, ga, sb, cb, gb = (mod[:, 0].clone(), mod[:, 1].clone(), mod[:, 2].clone(), mod[:, 3].clone(), mod[:, 4].clone(), mod[:, 5].clone())
    h = _layernorm(x, axis=-1) * (1 + ca) + sa
    x = x + ga * _A_ref(h, A_A_re, A_A_im, A_B_re, A_B_im, A_C_re, A_C_im, A_log_dt, A_Dskip)
    h = _layernorm(x, axis=-1) * (1 + cb) + sb
    x = x + gb * _B_ref(h, B_w_gate, B_w_up, B_w_down)
    return x
```

```asm
; @launch grid=(256,1,1) block=(512,1,1) lds=163840
.amdgcn_target "amdgcn-amd-amdhsa--gfx950"
.text
.globl adaLN_cond__ssm_conv_s4__glu_gated_bilinear__prompt_kernel
.p2align 8
.type adaLN_cond__ssm_conv_s4__glu_gated_bilinear__prompt_kernel,@function
adaLN_cond__ssm_conv_s4__glu_gated_bilinear__prompt_kernel:
    s_load_dwordx16 s[16:31], s[0:1], 0
    s_load_dwordx16 s[32:47], s[0:1], 64
    s_load_dwordx4 s[48:51], s[0:1], 128
    s_cmp_ge_u32 s2, 256
    s_cbranch_scc1 L_end
    s_and_b32 s4, s2, 7
    s_lshr_b32 s5, s2, 3
    v_lshrrev_b32 v2, 6, v0
    v_and_b32 v1, 63, v0
    v_readfirstlane_b32 s6, v2
    s_mul_i32 s10, s4, 28
    s_min_u32 s3, s5, 27
    s_add_u32 s10, s10, s3
    v_mov_b32 v2, 0
    v_lshlrev_b32 v3, 2, v1
    v_add_u32 v3, 160768, v3
    ds_write_b32 v3, v2
    ds_write_b32 v3, v2 offset:256
    v_and_b32 v0, 255, v0
    s_cmp_lt_u32 s6, 4
    s_cbranch_scc0 L_g1
    v_and_b32 v3, 1, v1
    v_mul_u32_u24 v3, 3088, v3
    v_add_u32 v3, 110080, v3
    ds_write_b32 v3, v2
    s_lshl_b32 s15, s10, 10
    v_lshl_add_u32 v3, v0, 2, s15
    s_lshl_b32 s12, s10, 2
    s_waitcnt lgkmcnt(0)
    global_load_dword v6, v3, s[18:19] nt
    global_load_dword v7, v3, s[20:21] nt
    global_load_dword v8, v3, s[22:23] nt
    global_load_dword v9, v3, s[24:25] nt
    global_load_dword v10, v3, s[26:27] nt
    global_load_dword v11, v3, s[28:29] nt
    s_load_dword s7, s[50:51], 0
    s_load_dword s13, s[30:31], s12
    s_load_dword s14, s[32:33], s12
    s_barrier
    s_lshr_b32 s16, s4, 2
    s_lshl_b32 s16, s16, 3
    s_lshr_b32 s3, s5, 2
    s_add_u32 s16, s16, s3
    s_and_b32 s17, s4, 3
    s_lshl_b32 s17, s17, 2
    s_and_b32 s3, s5, 3
    s_add_u32 s17, s17, s3
    s_mul_i32 s3, s5, 37
    s_lshr_b32 s3, s3, 8
    s_lshl_b32 s18, s4, 2
    s_add_u32 s18, s18, s3
    s_mul_i32 s3, s3, 7
    s_sub_u32 s19, s5, s3
    s_add_u32 s52, s50, 2883584
    s_addc_u32 s53, s51, 0
    s_mov_b32 s54, 1835008
    s_mov_b32 s55, 0x20000
    s_add_u32 s36, s50, 1048576
    s_addc_u32 s37, s51, 0
    s_mov_b32 s38, 1835008
    s_mov_b32 s39, 0x20000
    s_mul_i32 s3, s17, 204288
    s_add_u32 s3, s3, 4718592
    s_add_u32 s56, s50, s3
    s_addc_u32 s57, s51, 0
    s_mov_b32 s58, 204288
    s_mov_b32 s59, 0x20000
    s_mov_b32 s20, s40
    s_mov_b32 s21, s41
    s_mov_b32 s22, 1605632
    s_mov_b32 s23, 0x20000
    s_add_u32 s24, s50, 9830400
    s_addc_u32 s25, s51, 0
    s_mov_b32 s26, 7340032
    s_mov_b32 s27, 0x20000
    s_waitcnt lgkmcnt(0)
    s_add_u32 s7, s7, 1
    s_cmp_lt_u32 s5, 28
    s_cbranch_scc1 L_isconv
    s_waitcnt vmcnt(0)
    s_mov_b32 s64, 0
    v_mov_b32 v2, 160832
lf_1:
    ds_read_b128 v[12:15], v2
    s_waitcnt lgkmcnt(0)
    v_and_b32 v12, v12, v13
    v_and_b32 v14, v14, v15
    v_and_b32 v12, v12, v14
    v_cmp_eq_u32 vcc, 0, v12
    s_cbranch_vccz lfd_2
    s_add_u32 s64, s64, 1
    s_cmp_lt_u32 s64, 400000
    s_cbranch_scc1 lf_1
lfd_2:
    s_lshl_b32 s15, s4, 2
    s_add_u32 s15, s15, s5
    s_sub_u32 s15, s15, 28
    s_mul_i32 s15, s15, 50176
    v_lshlrev_b32 v2, 7, v0
    v_min_u32 v3, 135, v0
    v_lshlrev_b32 v3, 7, v3
    v_add_u32 v3, 32768, v3
    buffer_load_dword v12, v2, s[20:23], s15 offen
    buffer_load_dword v13, v3, s[20:23], s15 offen
    s_waitcnt vmcnt(0)
    s_branch L_g0b
L_isconv:
    s_lshl_b32 s15, s13, 16
    s_and_b32 s3, s13, 0xffff0000
    s_cmp_lt_u32 s6, 2
    s_cselect_b32 s15, s15, s3
    v_mov_b32 v2, s15
    v_mul_f32 v3, 0x3fb8aa3b, v2
    s_mov_b32 s3, 0x3fb8aa3b
    v_fma_f32 v4, v2, s3, -v3
    v_fmac_f32 v4, 0x32a57060, v2
    v_exp_f32 v3, v3
    v_mul_f32 v4, 0x3f317218, v4
    v_fmac_f32 v3, v3, v4
    v_cvt_pk_bf16_f32 v26, v3, v3
    v_and_b32 v26, 0xffff0000, v26
    v_lshlrev_b32 v2, 3, v0
    v_sub_u32 v2, 2047, v2
    v_cmp_lt_u32 vcc, 256, v2
    v_mov_b32 v5, 110084
    v_subrev_u32 v12, 0, v2
    v_cvt_f32_i32 v3, v12
    v_cvt_pk_bf16_f32 v3, v3, v3
    v_lshrrev_b32 v3, 16, v3
    v_subrev_u32 v3, 0x4280, v3
    v_cndmask_b32 v12, v12, v3, vcc
    v_lshl_add_u32 v12, v12, 2, v5
    v_subrev_u32 v13, 1, v2
    v_cvt_f32_i32 v3, v13
    v_cvt_pk_bf16_f32 v3, v3, v3
    v_lshrrev_b32 v3, 16, v3
    v_subrev_u32 v3, 0x4280, v3
    v_cndmask_b32 v13, v13, v3, vcc
    v_lshl_add_u32 v13, v13, 2, v5
    v_subrev_u32 v14, 2, v2
    v_cvt_f32_i32 v3, v14
    v_cvt_pk_bf16_f32 v3, v3, v3
    v_lshrrev_b32 v3, 16, v3
    v_subrev_u32 v3, 0x4280, v3
    v_cndmask_b32 v14, v14, v3, vcc
    v_lshl_add_u32 v14, v14, 2, v5
    v_subrev_u32 v15, 3, v2
    v_cvt_f32_i32 v3, v15
    v_cvt_pk_bf16_f32 v3, v3, v3
    v_lshrrev_b32 v3, 16, v3
    v_subrev_u32 v3, 0x4280, v3
    v_cndmask_b32 v15, v15, v3, vcc
    v_lshl_add_u32 v15, v15, 2, v5
    v_subrev_u32 v16, 4, v2
    v_cvt_f32_i32 v3, v16
    v_cvt_pk_bf16_f32 v3, v3, v3
    v_lshrrev_b32 v3, 16, v3
    v_subrev_u32 v3, 0x4280, v3
    v_cndmask_b32 v16, v16, v3, vcc
    v_lshl_add_u32 v16, v16, 2, v5
    v_subrev_u32 v17, 5, v2
    v_cvt_f32_i32 v3, v17
    v_cvt_pk_bf16_f32 v3, v3, v3
    v_lshrrev_b32 v3, 16, v3
    v_subrev_u32 v3, 0x4280, v3
    v_cndmask_b32 v17, v17, v3, vcc
    v_lshl_add_u32 v17, v17, 2, v5
    v_subrev_u32 v18, 6, v2
    v_cvt_f32_i32 v3, v18
    v_cvt_pk_bf16_f32 v3, v3, v3
    v_lshrrev_b32 v3, 16, v3
    v_subrev_u32 v3, 0x4280, v3
    v_cndmask_b32 v18, v18, v3, vcc
    v_lshl_add_u32 v18, v18, 2, v5
    v_subrev_u32 v19, 7, v2
    v_cvt_f32_i32 v3, v19
    v_cvt_pk_bf16_f32 v3, v3, v3
    v_lshrrev_b32 v3, 16, v3
    v_subrev_u32 v3, 0x4280, v3
    v_cndmask_b32 v19, v19, v3, vcc
    v_lshl_add_u32 v19, v19, 2, v5
    v_subrev_u32 v20, 8, v2
    v_cvt_f32_i32 v3, v20
    v_cvt_pk_bf16_f32 v3, v3, v3
    v_lshrrev_b32 v3, 16, v3
    v_subrev_u32 v3, 0x4280, v3
    v_cndmask_b32 v20, v20, v3, vcc
    v_lshl_add_u32 v20, v20, 2, v5
    v_lshrrev_b32 v3, 4, v0
    v_and_b32 v4, 15, v0
    v_mul_u32_u24 v21, 2064, v3
    v_lshl_add_u32 v21, v4, 4, v21
    v_and_b32 v24, 3, v3
    v_lshrrev_b32 v3, 2, v3
    v_lshl_add_u32 v24, v3, 3, v24
    v_lshrrev_b32 v3, 3, v4
    v_lshl_add_u32 v24, v3, 2, v24
    v_and_b32 v4, 7, v4
    v_lshlrev_b32 v4, 2, v4
    v_mov_b32 v22, v24
    v_mov_b32 v23, 8
    v_cmp_le_u32 vcc, 8, v24
    v_add_u32 v3, 248, v24
    s_nop 0
    v_cndmask_b32 v22, v22, v3, vcc
    v_cndmask_b32 v23, v23, 4, vcc
    v_cmp_le_u32 vcc, 12, v24
    v_and_b32 v3, 1, v24
    v_bfe_u32 v25, v24, 1, 1
    v_lshl_add_u32 v3, v25, 6, v3
    v_add_u32 v3, 384, v3
    v_cndmask_b32 v22, v22, v3, vcc
    v_cndmask_b32 v23, v23, 2, vcc
    v_cmp_le_u32 vcc, 16, v24
    v_lshlrev_b32 v3, 5, v24
    s_nop 0
    v_cndmask_b32 v22, v22, v3, vcc
    v_cndmask_b32 v23, v23, 1, vcc
    v_mad_u32_u24 v22, v23, v4, v22
    v_lshl_add_u32 v22, v22, 2, v5
    v_lshlrev_b32 v23, 2, v23
    v_mov_b32 v90, v26
    v_mov_b32 v91, v26
    s_lshl_b32 s15, s6, 9
    s_mov_b32 m0, s15
    s_waitcnt vmcnt(0)
    v_lshlrev_b32 v24, 16, v6
    v_and_b32 v25, 0xffff0000, v6
    v_lshlrev_b32 v28, 16, v7
    v_and_b32 v29, 0xffff0000, v7
    v_lshlrev_b32 v30, 16, v8
    v_and_b32 v31, 0xffff0000, v8
    v_lshlrev_b32 v32, 16, v9
    v_and_b32 v33, 0xffff0000, v9
    v_lshlrev_b32 v34, 16, v10
    v_and_b32 v35, 0xffff0000, v10
    v_lshlrev_b32 v36, 16, v11
    v_and_b32 v37, 0xffff0000, v11
    v_pk_mul_f32 v[24:25], v[24:25], v[90:91]
    v_pk_mul_f32 v[28:29], v[28:29], v[90:91]
    v_pk_mul_f32 v[30:31], v[30:31], v[90:91]
    v_pk_mul_f32 v[32:33], v[32:33], v[90:91]
    v_mul_f32 v24, 0x3fb8aa3b, v24
    v_mul_f32 v28, 0x3e22f983, v28
    v_mul_f32 v25, 0x3fb8aa3b, v25
    v_mul_f32 v29, 0x3e22f983, v29
    v_exp_f32 v82, v24
    v_fract_f32 v84, v28
    v_mul_f32 v86, 0x43800000, v24
    v_mul_f32 v88, 0x43800000, v28
    v_exp_f32 v83, v25
    v_fract_f32 v85, v29
    v_mul_f32 v87, 0x43800000, v25
    v_mul_f32 v89, 0x43800000, v29
    v_cos_f32 v40, v84
    v_sin_f32 v41, v84
    v_exp_f32 v86, v86
    v_fract_f32 v88, v88
    v_cos_f32 v62, v85
    v_sin_f32 v63, v85
    v_exp_f32 v87, v87
    v_fract_f32 v89, v89
    v_mul_f32 v38, v34, v30
    v_mul_f32 v39, v34, v32
    v_mul_f32 v40, v82, v40
    v_mul_f32 v41, v82, v41
    v_cos_f32 v48, v88
    v_sin_f32 v49, v88
    v_fma_f32 v38, -v36, v32, v38
    v_fmac_f32 v39, v36, v30
    v_mul_f32 v60, v35, v31
    v_mul_f32 v61, v35, v33
    v_mul_f32 v62, v83, v62
    v_mul_f32 v63, v83, v63
    v_cos_f32 v70, v89
    v_sin_f32 v71, v89
    v_fma_f32 v60, -v37, v33, v60
    v_fmac_f32 v61, v37, v31
    v_pk_mul_f32 v[50:51], v[40:41], v[40:41] op_sel:[0,0] op_sel_hi:[1,0]
    v_pk_mul_f32 v[72:73], v[62:63], v[62:63] op_sel:[0,0] op_sel_hi:[1,0]
    v_pk_fma_f32 v[42:43], v[40:41], v[40:41], v[50:51] op_sel:[1,1,0] op_sel_hi:[0,1,1] neg_lo:[1,0,0]
    v_pk_fma_f32 v[64:65], v[62:63], v[62:63], v[72:73] op_sel:[1,1,0] op_sel_hi:[0,1,1] neg_lo:[1,0,0]
    v_mul_f32 v48, v86, v48
    v_mul_f32 v49, v86, v49
    v_mul_f32 v70, v87, v70
    v_mul_f32 v71, v87, v71
    v_cvt_pk_bf16_f32 v92, v38, -v39
    v_cvt_pk_bf16_f32 v93, v60, -v61
    ds_write_addtid_b32 v92 offset:0
    ds_write_addtid_b32 v93 offset:256
    v_pk_mul_f32 v[50:51], v[42:43], v[42:43] op_sel:[0,0] op_sel_hi:[1,0]
    v_pk_mul_f32 v[72:73], v[64:65], v[64:65] op_sel:[0,0] op_sel_hi:[1,0]
    v_pk_fma_f32 v[44:45], v[42:43], v[42:43], v[50:51] op_sel:[1,1,0] op_sel_hi:[0,1,1] neg_lo:[1,0,0]
    v_pk_fma_f32 v[66:67], v[64:65], v[64:65], v[72:73] op_sel:[1,1,0] op_sel_hi:[0,1,1] neg_lo:[1,0,0]
    v_pk_mul_f32 v[52:53], v[38:39], v[40:41] op_sel:[0,0] op_sel_hi:[1,0]
    v_pk_mul_f32 v[74:75], v[60:61], v[62:63] op_sel:[0,0] op_sel_hi:[1,0]
    v_pk_fma_f32 v[54:55], v[38:39], v[40:41], v[52:53] op_sel:[1,1,0] op_sel_hi:[0,1,1] neg_lo:[1,0,0]
    v_pk_fma_f32 v[76:77], v[60:61], v[62:63], v[74:75] op_sel:[1,1,0] op_sel_hi:[0,1,1] neg_lo:[1,0,0]
    v_pk_mul_f32 v[50:51], v[44:45], v[44:45] op_sel:[0,0] op_sel_hi:[1,0]
    v_pk_mul_f32 v[72:73], v[66:67], v[66:67] op_sel:[0,0] op_sel_hi:[1,0]
    v_pk_fma_f32 v[46:47], v[44:45], v[44:45], v[50:51] op_sel:[1,1,0] op_sel_hi:[0,1,1] neg_lo:[1,0,0]
    v_pk_fma_f32 v[68:69], v[66:67], v[66:67], v[72:73] op_sel:[1,1,0] op_sel_hi:[0,1,1] neg_lo:[1,0,0]
    v_cvt_pk_bf16_f32 v94, v54, -v55
    v_cvt_pk_bf16_f32 v95, v76, -v77
    ds_write_addtid_b32 v94 offset:2064
    ds_write_addtid_b32 v95 offset:2320
    v_mov_b32 v2, 0x3f80
    ds_write_addtid_b32 v2 offset:43344
    ds_write_addtid_b32 v2 offset:43600
    v_cvt_pk_bf16_f32 v96, v46, v47
    v_cvt_pk_bf16_f32 v97, v68, v69
    ds_write_addtid_b32 v96 offset:45408
    ds_write_addtid_b32 v97 offset:45664
    v_pk_mul_f32 v[50:51], v[54:55], v[40:41] op_sel:[0,0] op_sel_hi:[1,0]
    v_pk_mul_f32 v[72:73], v[76:77], v[62:63] op_sel:[0,0] op_sel_hi:[1,0]
    v_pk_fma_f32 v[54:55], v[54:55], v[40:41], v[50:51] op_sel:[1,1,0] op_sel_hi:[0,1,1] neg_lo:[1,0,0]
    v_pk_fma_f32 v[76:77], v[76:77], v[62:63], v[72:73] op_sel:[1,1,0] op_sel_hi:[0,1,1] neg_lo:[1,0,0]
    v_pk_mul_f32 v[52:53], v[46:47], v[46:47] op_sel:[0,0] op_sel_hi:[1,0]
    v_pk_mul_f32 v[74:75], v[68:69], v[68:69] op_sel:[0,0] op_sel_hi:[1,0]
    v_pk_fma_f32 v[58:59], v[46:47], v[46:47], v[52:53] op_sel:[1,1,0] op_sel_hi:[0,1,1] neg_lo:[1,0,0]
    v_pk_fma_f32 v[80:81], v[68:69], v[68:69], v[74:75] op_sel:[1,1,0] op_sel_hi:[0,1,1] neg_lo:[1,0,0]
    v_cvt_pk_bf16_f32 v98, v54, -v55
    v_cvt_pk_bf16_f32 v99, v76, -v77
    ds_write_addtid_b32 v98 offset:4128
    ds_write_addtid_b32 v99 offset:4384
    v_cvt_pk_bf16_f32 v92, v58, v59
    v_cvt_pk_bf16_f32 v93, v80, v81
    ds_write_addtid_b32 v92 offset:47472
    ds_write_addtid_b32 v93 offset:47728
    v_pk_mul_f32 v[50:51], v[54:55], v[40:41] op_sel:[0,0] op_sel_hi:[1,0]
    v_pk_mul_f32 v[72:73], v[76:77], v[62:63] op_sel:[0,0] op_sel_hi:[1,0]
    v_pk_fma_f32 v[54:55], v[54:55], v[40:41], v[50:51] op_sel:[1,1,0] op_sel_hi:[0,1,1] neg_lo:[1,0,0]
    v_pk_fma_f32 v[76:77], v[76:77], v[62:63], v[72:73] op_sel:[1,1,0] op_sel_hi:[0,1,1] neg_lo:[1,0,0]
    v_pk_mul_f32 v[52:53], v[58:59], v[46:47] op_sel:[0,0] op_sel_hi:[1,0]
    v_pk_mul_f32 v[74:75], v[80:81], v[68:69] op_sel:[0,0] op_sel_hi:[1,0]
    v_pk_fma_f32 v[58:59], v[58:59], v[46:47], v[52:53] op_sel:[1,1,0] op_sel_hi:[0,1,1] neg_lo:[1,0,0]
    v_pk_fma_f32 v[80:81], v[80:81], v[68:69], v[74:75] op_sel:[1,1,0] op_sel_hi:[0,1,1] neg_lo:[1,0,0]
    v_cvt_pk_bf16_f32 v94, v54, -v55
    v_cvt_pk_bf16_f32 v95, v76, -v77
    ds_write_addtid_b32 v94 offset:6192
    ds_write_addtid_b32 v95 offset:6448
    v_cvt_pk_bf16_f32 v96, v58, v59
    v_cvt_pk_bf16_f32 v97, v80, v81
    ds_write_addtid_b32 v96 offset:49536
    ds_write_addtid_b32 v97 offset:49792
    v_pk_mul_f32 v[50:51], v[54:55], v[40:41] op_sel:[0,0] op_sel_hi:[1,0]
    v_pk_mul_f32 v[72:73], v[76:77], v[62:63] op_sel:[0,0] op_sel_hi:[1,0]
    v_pk_fma_f32 v[54:55], v[54:55], v[40:41], v[50:51] op_sel:[1,1,0] op_sel_hi:[0,1,1] neg_lo:[1,0,0]
    v_pk_fma_f32 v[76:77], v[76:77], v[62:63], v[72:73] op_sel:[1,1,0] op_sel_hi:[0,1,1] neg_lo:[1,0,0]
    v_pk_mul_f32 v[52:53], v[58:59], v[46:47] op_sel:[0,0] op_sel_hi:[1,0]
    v_pk_mul_f32 v[74:75], v[80:81], v[68:69] op_sel:[0,0] op_sel_hi:[1,0]
    v_pk_fma_f32 v[58:59], v[58:59], v[46:47], v[52:53] op_sel:[1,1,0] op_sel_hi:[0,1,1] neg_lo:[1,0,0]
    v_pk_fma_f32 v[80:81], v[80:81], v[68:69], v[74:75] op_sel:[1,1,0] op_sel_hi:[0,1,1] neg_lo:[1,0,0]
    v_cvt_pk_bf16_f32 v98, v54, -v55
    v_cvt_pk_bf16_f32 v99, v76, -v77
    ds_write_addtid_b32 v98 offset:8256
    ds_write_addtid_b32 v99 offset:8512
    v_cvt_pk_bf16_f32 v92, v58, v59
    v_cvt_pk_bf16_f32 v93, v80, v81
    ds_write_addtid_b32 v92 offset:51600
    ds_write_addtid_b32 v93 offset:51856
    v_pk_mul_f32 v[50:51], v[54:55], v[40:41] op_sel:[0,0] op_sel_hi:[1,0]
    v_pk_mul_f32 v[72:73], v[76:77], v[62:63] op_sel:[0,0] op_sel_hi:[1,0]
    v_pk_fma_f32 v[54:55], v[54:55], v[40:41], v[50:51] op_sel:[1,1,0] op_sel_hi:[0,1,1] neg_lo:[1,0,0]
    v_pk_fma_f32 v[76:77], v[76:77], v[62:63], v[72:73] op_sel:[1,1,0] op_sel_hi:[0,1,1] neg_lo:[1,0,0]
    v_pk_mul_f32 v[52:53], v[58:59], v[46:47] op_sel:[0,0] op_sel_hi:[1,0]
    v_pk_mul_f32 v[74:75], v[80:81], v[68:69] op_sel:[0,0] op_sel_hi:[1,0]
    v_pk_fma_f32 v[58:59], v[58:59], v[46:47], v[52:53] op_sel:[1,1,0] op_sel_hi:[0,1,1] neg_lo:[1,0,0]
    v_pk_fma_f32 v[80:81], v[80:81], v[68:69], v[74:75] op_sel:[1,1,0] op_sel_hi:[0,1,1] neg_lo:[1,0,0]
    v_cvt_pk_bf16_f32 v94, v54, -v55
    v_cvt_pk_bf16_f32 v95, v76, -v77
    ds_write_addtid_b32 v94 offset:10320
    ds_write_addtid_b32 v95 offset:10576
    v_cvt_pk_bf16_f32 v96, v58, v59
    v_cvt_pk_bf16_f32 v97, v80, v81
    ds_write_addtid_b32 v96 offset:53664
    ds_write_addtid_b32 v97 offset:53920
    v_pk_mul_f32 v[50:51], v[54:55], v[40:41] op_sel:[0,0] op_sel_hi:[1,0]
    v_pk_mul_f32 v[72:73], v[76:77], v[62:63] op_sel:[0,0] op_sel_hi:[1,0]
    v_pk_fma_f32 v[54:55], v[54:55], v[40:41], v[50:51] op_sel:[1,1,0] op_sel_hi:[0,1,1] neg_lo:[1,0,0]
    v_pk_fma_f32 v[76:77], v[76:77], v[62:63], v[72:73] op_sel:[1,1,0] op_sel_hi:[0,1,1] neg_lo:[1,0,0]
    v_pk_mul_f32 v[52:53], v[58:59], v[46:47] op_sel:[0,0] op_sel_hi:[1,0]
    v_pk_mul_f32 v[74:75], v[80:81], v[68:69] op_sel:[0,0] op_sel_hi:[1,0]
    v_pk_fma_f32 v[58:59], v[58:59], v[46:47], v[52:53] op_sel:[1,1,0] op_sel_hi:[0,1,1] neg_lo:[1,0,0]
    v_pk_fma_f32 v[80:81], v[80:81], v[68:69], v[74:75] op_sel:[1,1,0] op_sel_hi:[0,1,1] neg_lo:[1,0,0]
    v_cvt_pk_bf16_f32 v98, v54, -v55
    v_cvt_pk_bf16_f32 v99, v76, -v77
    ds_write_addtid_b32 v98 offset:12384
    ds_write_addtid_b32 v99 offset:12640
    v_cvt_pk_bf16_f32 v92, v58, v59
    v_cvt_pk_bf16_f32 v93, v80, v81
    ds_write_addtid_b32 v92 offset:55728
    ds_write_addtid_b32 v93 offset:55984
    v_pk_mul_f32 v[50:51], v[54:55], v[40:41] op_sel:[0,0] op_sel_hi:[1,0]
    v_pk_mul_f32 v[72:73], v[76:77], v[62:63] op_sel:[0,0] op_sel_hi:[1,0]
    v_pk_fma_f32 v[54:55], v[54:55], v[40:41], v[50:51] op_sel:[1,1,0] op_sel_hi:[0,1,1] neg_lo:[1,0,0]
    v_pk_fma_f32 v[76:77], v[76:77], v[62:63], v[72:73] op_sel:[1,1,0] op_sel_hi:[0,1,1] neg_lo:[1,0,0]
    v_pk_mul_f32 v[52:53], v[58:59], v[46:47] op_sel:[0,0] op_sel_hi:[1,0]
    v_pk_mul_f32 v[74:75], v[80:81], v[68:69] op_sel:[0,0] op_sel_hi:[1,0]
    v_pk_fma_f32 v[58:59], v[58:59], v[46:47], v[52:53] op_sel:[1,1,0] op_sel_hi:[0,1,1] neg_lo:[1,0,0]
    v_pk_fma_f32 v[80:81], v[80:81], v[68:69], v[74:75] op_sel:[1,1,0] op_sel_hi:[0,1,1] neg_lo:[1,0,0]
    v_cvt_pk_bf16_f32 v94, v54, -v55
    v_cvt_pk_bf16_f32 v95, v76, -v77
    ds_write_addtid_b32 v94 offset:14448
    ds_write_addtid_b32 v95 offset:14704
    v_cvt_pk_bf16_f32 v96, v58, v59
    v_cvt_pk_bf16_f32 v97, v80, v81
    ds_write_addtid_b32 v96 offset:57792
    ds_write_addtid_b32 v97 offset:58048
    v_pk_mul_f32 v[50:51], v[38:39], v[48:49] op_sel:[0,0] op_sel_hi:[1,0]
    v_pk_mul_f32 v[72:73], v[60:61], v[70:71] op_sel:[0,0] op_sel_hi:[1,0]
    v_pk_fma_f32 v[54:55], v[38:39], v[48:49], v[50:51] op_sel:[1,1,0] op_sel_hi:[0,1,1] neg_lo:[1,0,0]
    v_pk_fma_f32 v[76:77], v[60:61], v[70:71], v[72:73] op_sel:[1,1,0] op_sel_hi:[0,1,1] neg_lo:[1,0,0]
    v_pk_mul_f32 v[52:53], v[58:59], v[46:47] op_sel:[0,0] op_sel_hi:[1,0]
    v_pk_mul_f32 v[74:75], v[80:81], v[68:69] op_sel:[0,0] op_sel_hi:[1,0]
    v_pk_fma_f32 v[58:59], v[58:59], v[46:47], v[52:53] op_sel:[1,1,0] op_sel_hi:[0,1,1] neg_lo:[1,0,0]
    v_pk_fma_f32 v[80:81], v[80:81], v[68:69], v[74:75] op_sel:[1,1,0] op_sel_hi:[0,1,1] neg_lo:[1,0,0]
    v_cvt_pk_bf16_f32 v98, v54, -v55
    v_cvt_pk_bf16_f32 v99, v76, -v77
    ds_write_addtid_b32 v98 offset:16512
    ds_write_addtid_b32 v99 offset:16768
    v_cvt_pk_bf16_f32 v92, v58, v59
    v_cvt_pk_bf16_f32 v93, v80, v81
    ds_write_addtid_b32 v92 offset:59856
    ds_write_addtid_b32 v93 offset:60112
    v_pk_mul_f32 v[50:51], v[54:55], v[48:49] op_sel:[0,0] op_sel_hi:[1,0]
    v_pk_mul_f32 v[72:73], v[76:77], v[70:71] op_sel:[0,0] op_sel_hi:[1,0]
    v_pk_fma_f32 v[56:57], v[54:55], v[48:49], v[50:51] op_sel:[1,1,0] op_sel_hi:[0,1,1] neg_lo:[1,0,0]
    v_pk_fma_f32 v[78:79], v[76:77], v[70:71], v[72:73] op_sel:[1,1,0] op_sel_hi:[0,1,1] neg_lo:[1,0,0]
    v_cvt_pk_bf16_f32 v94, v56, -v57
    v_cvt_pk_bf16_f32 v95, v78, -v79
    ds_write_addtid_b32 v94 offset:24768
    ds_write_addtid_b32 v95 offset:25024
    v_pk_mul_f32 v[50:51], v[54:55], v[42:43] op_sel:[0,0] op_sel_hi:[1,0]
    v_pk_mul_f32 v[72:73], v[76:77], v[64:65] op_sel:[0,0] op_sel_hi:[1,0]
    v_pk_fma_f32 v[54:55], v[54:55], v[42:43], v[50:51] op_sel:[1,1,0] op_sel_hi:[0,1,1] neg_lo:[1,0,0]
    v_pk_fma_f32 v[76:77], v[76:77], v[64:65], v[72:73] op_sel:[1,1,0] op_sel_hi:[0,1,1] neg_lo:[1,0,0]
    v_cvt_pk_bf16_f32 v96, v54, -v55
    v_cvt_pk_bf16_f32 v97, v76, -v77
    ds_write_addtid_b32 v96 offset:18576
    ds_write_addtid_b32 v97 offset:18832
    v_pk_mul_f32 v[50:51], v[54:55], v[42:43] op_sel:[0,0] op_sel_hi:[1,0]
    v_pk_mul_f32 v[72:73], v[76:77], v[64:65] op_sel:[0,0] op_sel_hi:[1,0]
    v_pk_fma_f32 v[54:55], v[54:55], v[42:43], v[50:51] op_sel:[1,1,0] op_sel_hi:[0,1,1] neg_lo:[1,0,0]
    v_pk_fma_f32 v[76:77], v[76:77], v[64:65], v[72:73] op_sel:[1,1,0] op_sel_hi:[0,1,1] neg_lo:[1,0,0]
    v_cvt_pk_bf16_f32 v98, v54, -v55
    v_cvt_pk_bf16_f32 v99, v76, -v77
    ds_write_addtid_b32 v98 offset:20640
    ds_write_addtid_b32 v99 offset:20896
    v_pk_mul_f32 v[50:51], v[54:55], v[42:43] op_sel:[0,0] op_sel_hi:[1,0]
    v_pk_mul_f32 v[72:73], v[76:77], v[64:65] op_sel:[0,0] op_sel_hi:[1,0]
    v_pk_fma_f32 v[54:55], v[54:55], v[42:43], v[50:51] op_sel:[1,1,0] op_sel_hi:[0,1,1] neg_lo:[1,0,0]
    v_pk_fma_f32 v[76:77], v[76:77], v[64:65], v[72:73] op_sel:[1,1,0] op_sel_hi:[0,1,1] neg_lo:[1,0,0]
    v_cvt_pk_bf16_f32 v92, v54, -v55
    v_cvt_pk_bf16_f32 v93, v76, -v77
    ds_write_addtid_b32 v92 offset:22704
    ds_write_addtid_b32 v93 offset:22960
    v_pk_mul_f32 v[50:51], v[56:57], v[44:45] op_sel:[0,0] op_sel_hi:[1,0]
    v_pk_mul_f32 v[72:73], v[78:79], v[66:67] op_sel:[0,0] op_sel_hi:[1,0]
    v_pk_fma_f32 v[54:55], v[56:57], v[44:45], v[50:51] op_sel:[1,1,0] op_sel_hi:[0,1,1] neg_lo:[1,0,0]
    v_pk_fma_f32 v[76:77], v[78:79], v[66:67], v[72:73] op_sel:[1,1,0] op_sel_hi:[0,1,1] neg_lo:[1,0,0]
    v_cvt_pk_bf16_f32 v94, v54, -v55
    v_cvt_pk_bf16_f32 v95, v76, -v77
    ds_write_addtid_b32 v94 offset:26832
    ds_write_addtid_b32 v95 offset:27088
    v_pk_mul_f32 v[50:51], v[54:55], v[48:49] op_sel:[0,0] op_sel_hi:[1,0]
    v_pk_mul_f32 v[72:73], v[76:77], v[70:71] op_sel:[0,0] op_sel_hi:[1,0]
    v_pk_fma_f32 v[54:55], v[54:55], v[48:49], v[50:51] op_sel:[1,1,0] op_sel_hi:[0,1,1] neg_lo:[1,0,0]
    v_pk_fma_f32 v[76:77], v[76:77], v[70:71], v[72:73] op_sel:[1,1,0] op_sel_hi:[0,1,1] neg_lo:[1,0,0]
    v_cvt_pk_bf16_f32 v96, v54, -v55
    v_cvt_pk_bf16_f32 v97, v76, -v77
    ds_write_addtid_b32 v96 offset:30960
    ds_write_addtid_b32 v97 offset:31216
    v_pk_mul_f32 v[50:51], v[56:57], v[48:49] op_sel:[0,0] op_sel_hi:[1,0]
    v_pk_mul_f32 v[72:73], v[78:79], v[70:71] op_sel:[0,0] op_sel_hi:[1,0]
    v_pk_fma_f32 v[56:57], v[56:57], v[48:49], v[50:51] op_sel:[1,1,0] op_sel_hi:[0,1,1] neg_lo:[1,0,0]
    v_pk_fma_f32 v[78:79], v[78:79], v[70:71], v[72:73] op_sel:[1,1,0] op_sel_hi:[0,1,1] neg_lo:[1,0,0]
    v_cvt_pk_bf16_f32 v98, v56, -v57
    v_cvt_pk_bf16_f32 v99, v78, -v79
    ds_write_addtid_b32 v98 offset:28896
    ds_write_addtid_b32 v99 offset:29152
    v_pk_mul_f32 v[50:51], v[56:57], v[48:49] op_sel:[0,0] op_sel_hi:[1,0]
    v_pk_mul_f32 v[72:73], v[78:79], v[70:71] op_sel:[0,0] op_sel_hi:[1,0]
    v_pk_fma_f32 v[56:57], v[56:57], v[48:49], v[50:51] op_sel:[1,1,0] op_sel_hi:[0,1,1] neg_lo:[1,0,0]
    v_pk_fma_f32 v[78:79], v[78:79], v[70:71], v[72:73] op_sel:[1,1,0] op_sel_hi:[0,1,1] neg_lo:[1,0,0]
    v_cvt_pk_bf16_f32 v92, v56, -v57
    v_cvt_pk_bf16_f32 v93, v78, -v79
    ds_write_addtid_b32 v92 offset:33024
    ds_write_addtid_b32 v93 offset:33280
    v_pk_mul_f32 v[50:51], v[56:57], v[48:49] op_sel:[0,0] op_sel_hi:[1,0]
    v_pk_mul_f32 v[72:73], v[78:79], v[70:71] op_sel:[0,0] op_sel_hi:[1,0]
    v_pk_fma_f32 v[56:57], v[56:57], v[48:49], v[50:51] op_sel:[1,1,0] op_sel_hi:[0,1,1] neg_lo:[1,0,0]
    v_pk_fma_f32 v[78:79], v[78:79], v[70:71], v[72:73] op_sel:[1,1,0] op_sel_hi:[0,1,1] neg_lo:[1,0,0]
    v_cvt_pk_bf16_f32 v94, v56, -v57
    v_cvt_pk_bf16_f32 v95, v78, -v79
    ds_write_addtid_b32 v94 offset:35088
    ds_write_addtid_b32 v95 offset:35344
    v_pk_mul_f32 v[50:51], v[56:57], v[48:49] op_sel:[0,0] op_sel_hi:[1,0]
    v_pk_mul_f32 v[72:73], v[78:79], v[70:71] op_sel:[0,0] op_sel_hi:[1,0]
    v_pk_fma_f32 v[56:57], v[56:57], v[48:49], v[50:51] op_sel:[1,1,0] op_sel_hi:[0,1,1] neg_lo:[1,0,0]
    v_pk_fma_f32 v[78:79], v[78:79], v[70:71], v[72:73] op_sel:[1,1,0] op_sel_hi:[0,1,1] neg_lo:[1,0,0]
    v_cvt_pk_bf16_f32 v96, v56, -v57
    v_cvt_pk_bf16_f32 v97, v78, -v79
    ds_write_addtid_b32 v96 offset:37152
    ds_write_addtid_b32 v97 offset:37408
    v_pk_mul_f32 v[50:51], v[56:57], v[48:49] op_sel:[0,0] op_sel_hi:[1,0]
    v_pk_mul_f32 v[72:73], v[78:79], v[70:71] op_sel:[0,0] op_sel_hi:[1,0]
    v_pk_fma_f32 v[56:57], v[56:57], v[48:49], v[50:51] op_sel:[1,1,0] op_sel_hi:[0,1,1] neg_lo:[1,0,0]
    v_pk_fma_f32 v[78:79], v[78:79], v[70:71], v[72:73] op_sel:[1,1,0] op_sel_hi:[0,1,1] neg_lo:[1,0,0]
    v_cvt_pk_bf16_f32 v98, v56, -v57
    v_cvt_pk_bf16_f32 v99, v78, -v79
    ds_write_addtid_b32 v98 offset:39216
    ds_write_addtid_b32 v99 offset:39472
    v_pk_mul_f32 v[50:51], v[56:57], v[48:49] op_sel:[0,0] op_sel_hi:[1,0]
    v_pk_mul_f32 v[72:73], v[78:79], v[70:71] op_sel:[0,0] op_sel_hi:[1,0]
    v_pk_fma_f32 v[56:57], v[56:57], v[48:49], v[50:51] op_sel:[1,1,0] op_sel_hi:[0,1,1] neg_lo:[1,0,0]
    v_pk_fma_f32 v[78:79], v[78:79], v[70:71], v[72:73] op_sel:[1,1,0] op_sel_hi:[0,1,1] neg_lo:[1,0,0]
    v_cvt_pk_bf16_f32 v92, v56, -v57
    v_cvt_pk_bf16_f32 v93, v78, -v79
    ds_write_addtid_b32 v92 offset:41280
    ds_write_addtid_b32 v93 offset:41536
    v_pk_mul_f32 v[50:51], v[58:59], v[46:47] op_sel:[0,0] op_sel_hi:[1,0]
    v_pk_mul_f32 v[72:73], v[80:81], v[68:69] op_sel:[0,0] op_sel_hi:[1,0]
    v_pk_fma_f32 v[58:59], v[58:59], v[46:47], v[50:51] op_sel:[1,1,0] op_sel_hi:[0,1,1] neg_lo:[1,0,0]
    v_pk_fma_f32 v[80:81], v[80:81], v[68:69], v[72:73] op_sel:[1,1,0] op_sel_hi:[0,1,1] neg_lo:[1,0,0]
    v_cvt_pk_bf16_f32 v94, v58, v59
    v_cvt_pk_bf16_f32 v95, v80, v81
    s_add_u32 m0, s15, 61920
    s_nop 0
    ds_write_addtid_b32 v94 offset:0
    ds_write_addtid_b32 v95 offset:256
    v_pk_mul_f32 v[50:51], v[58:59], v[46:47] op_sel:[0,0] op_sel_hi:[1,0]
    v_pk_mul_f32 v[72:73], v[80:81], v[68:69] op_sel:[0,0] op_sel_hi:[1,0]
    v_pk_fma_f32 v[58:59], v[58:59], v[46:47], v[50:51] op_sel:[1,1,0] op_sel_hi:[0,1,1] neg_lo:[1,0,0]
    v_pk_fma_f32 v[80:81], v[80:81], v[68:69], v[72:73] op_sel:[1,1,0] op_sel_hi:[0,1,1] neg_lo:[1,0,0]
    v_cvt_pk_bf16_f32 v96, v58, v59
    v_cvt_pk_bf16_f32 v97, v80, v81
    ds_write_addtid_b32 v96 offset:2064
    ds_write_addtid_b32 v97 offset:2320
    v_pk_mul_f32 v[50:51], v[58:59], v[46:47] op_sel:[0,0] op_sel_hi:[1,0]
    v_pk_mul_f32 v[72:73], v[80:81], v[68:69] op_sel:[0,0] op_sel_hi:[1,0]
    v_pk_fma_f32 v[58:59], v[58:59], v[46:47], v[50:51] op_sel:[1,1,0] op_sel_hi:[0,1,1] neg_lo:[1,0,0]
    v_pk_fma_f32 v[80:81], v[80:81], v[68:69], v[72:73] op_sel:[1,1,0] op_sel_hi:[0,1,1] neg_lo:[1,0,0]
    v_cvt_pk_bf16_f32 v98, v58, v59
    v_cvt_pk_bf16_f32 v99, v80, v81
    ds_write_addtid_b32 v98 offset:4128
    ds_write_addtid_b32 v99 offset:4384
    v_pk_mul_f32 v[50:51], v[58:59], v[46:47] op_sel:[0,0] op_sel_hi:[1,0]
    v_pk_mul_f32 v[72:73], v[80:81], v[68:69] op_sel:[0,0] op_sel_hi:[1,0]
    v_pk_fma_f32 v[58:59], v[58:59], v[46:47], v[50:51] op_sel:[1,1,0] op_sel_hi:[0,1,1] neg_lo:[1,0,0]
    v_pk_fma_f32 v[80:81], v[80:81], v[68:69], v[72:73] op_sel:[1,1,0] op_sel_hi:[0,1,1] neg_lo:[1,0,0]
    v_cvt_pk_bf16_f32 v92, v58, v59
    v_cvt_pk_bf16_f32 v93, v80, v81
    ds_write_addtid_b32 v92 offset:6192
    ds_write_addtid_b32 v93 offset:6448
    v_pk_mul_f32 v[50:51], v[58:59], v[46:47] op_sel:[0,0] op_sel_hi:[1,0]
    v_pk_mul_f32 v[72:73], v[80:81], v[68:69] op_sel:[0,0] op_sel_hi:[1,0]
    v_pk_fma_f32 v[58:59], v[58:59], v[46:47], v[50:51] op_sel:[1,1,0] op_sel_hi:[0,1,1] neg_lo:[1,0,0]
    v_pk_fma_f32 v[80:81], v[80:81], v[68:69], v[72:73] op_sel:[1,1,0] op_sel_hi:[0,1,1] neg_lo:[1,0,0]
    v_cvt_pk_bf16_f32 v94, v58, v59
    v_cvt_pk_bf16_f32 v95, v80, v81
    ds_write_addtid_b32 v94 offset:8256
    ds_write_addtid_b32 v95 offset:8512
    v_pk_mul_f32 v[50:51], v[58:59], v[46:47] op_sel:[0,0] op_sel_hi:[1,0]
    v_pk_mul_f32 v[72:73], v[80:81], v[68:69] op_sel:[0,0] op_sel_hi:[1,0]
    v_pk_fma_f32 v[58:59], v[58:59], v[46:47], v[50:51] op_sel:[1,1,0] op_sel_hi:[0,1,1] neg_lo:[1,0,0]
    v_pk_fma_f32 v[80:81], v[80:81], v[68:69], v[72:73] op_sel:[1,1,0] op_sel_hi:[0,1,1] neg_lo:[1,0,0]
    v_cvt_pk_bf16_f32 v96, v58, v59
    v_cvt_pk_bf16_f32 v97, v80, v81
    ds_write_addtid_b32 v96 offset:10320
    ds_write_addtid_b32 v97 offset:10576
    v_pk_mul_f32 v[50:51], v[58:59], v[46:47] op_sel:[0,0] op_sel_hi:[1,0]
    v_pk_mul_f32 v[72:73], v[80:81], v[68:69] op_sel:[0,0] op_sel_hi:[1,0]
    v_pk_fma_f32 v[58:59], v[58:59], v[46:47], v[50:51] op_sel:[1,1,0] op_sel_hi:[0,1,1] neg_lo:[1,0,0]
    v_pk_fma_f32 v[80:81], v[80:81], v[68:69], v[72:73] op_sel:[1,1,0] op_sel_hi:[0,1,1] neg_lo:[1,0,0]
    v_cvt_pk_bf16_f32 v98, v58, v59
    v_cvt_pk_bf16_f32 v99, v80, v81
    ds_write_addtid_b32 v98 offset:12384
    ds_write_addtid_b32 v99 offset:12640
    v_pk_mul_f32 v[50:51], v[58:59], v[46:47] op_sel:[0,0] op_sel_hi:[1,0]
    v_pk_mul_f32 v[72:73], v[80:81], v[68:69] op_sel:[0,0] op_sel_hi:[1,0]
    v_pk_fma_f32 v[58:59], v[58:59], v[46:47], v[50:51] op_sel:[1,1,0] op_sel_hi:[0,1,1] neg_lo:[1,0,0]
    v_pk_fma_f32 v[80:81], v[80:81], v[68:69], v[72:73] op_sel:[1,1,0] op_sel_hi:[0,1,1] neg_lo:[1,0,0]
    v_cvt_pk_bf16_f32 v92, v58, v59
    v_cvt_pk_bf16_f32 v93, v80, v81
    ds_write_addtid_b32 v92 offset:14448
    ds_write_addtid_b32 v93 offset:14704
    v_pk_mul_f32 v[50:51], v[58:59], v[46:47] op_sel:[0,0] op_sel_hi:[1,0]
    v_pk_mul_f32 v[72:73], v[80:81], v[68:69] op_sel:[0,0] op_sel_hi:[1,0]
    v_pk_fma_f32 v[58:59], v[58:59], v[46:47], v[50:51] op_sel:[1,1,0] op_sel_hi:[0,1,1] neg_lo:[1,0,0]
    v_pk_fma_f32 v[80:81], v[80:81], v[68:69], v[72:73] op_sel:[1,1,0] op_sel_hi:[0,1,1] neg_lo:[1,0,0]
    v_cvt_pk_bf16_f32 v94, v58, v59
    v_cvt_pk_bf16_f32 v95, v80, v81
    ds_write_addtid_b32 v94 offset:16512
    ds_write_addtid_b32 v95 offset:16768
    v_pk_mul_f32 v[50:51], v[58:59], v[46:47] op_sel:[0,0] op_sel_hi:[1,0]
    v_pk_mul_f32 v[72:73], v[80:81], v[68:69] op_sel:[0,0] op_sel_hi:[1,0]
    v_pk_fma_f32 v[58:59], v[58:59], v[46:47], v[50:51] op_sel:[1,1,0] op_sel_hi:[0,1,1] neg_lo:[1,0,0]
    v_pk_fma_f32 v[80:81], v[80:81], v[68:69], v[72:73] op_sel:[1,1,0] op_sel_hi:[0,1,1] neg_lo:[1,0,0]
    v_cvt_pk_bf16_f32 v96, v58, v59
    v_cvt_pk_bf16_f32 v97, v80, v81
    ds_write_addtid_b32 v96 offset:18576
    ds_write_addtid_b32 v97 offset:18832
    v_pk_mul_f32 v[50:51], v[58:59], v[46:47] op_sel:[0,0] op_sel_hi:[1,0]
    v_pk_mul_f32 v[72:73], v[80:81], v[68:69] op_sel:[0,0] op_sel_hi:[1,0]
    v_pk_fma_f32 v[58:59], v[58:59], v[46:47], v[50:51] op_sel:[1,1,0] op_sel_hi:[0,1,1] neg_lo:[1,0,0]
    v_pk_fma_f32 v[80:81], v[80:81], v[68:69], v[72:73] op_sel:[1,1,0] op_sel_hi:[0,1,1] neg_lo:[1,0,0]
    v_cvt_pk_bf16_f32 v98, v58, v59
    v_cvt_pk_bf16_f32 v99, v80, v81
    ds_write_addtid_b32 v98 offset:20640
    ds_write_addtid_b32 v99 offset:20896
    v_pk_mul_f32 v[50:51], v[58:59], v[46:47] op_sel:[0,0] op_sel_hi:[1,0]
    v_pk_mul_f32 v[72:73], v[80:81], v[68:69] op_sel:[0,0] op_sel_hi:[1,0]
    v_pk_fma_f32 v[58:59], v[58:59], v[46:47], v[50:51] op_sel:[1,1,0] op_sel_hi:[0,1,1] neg_lo:[1,0,0]
    v_pk_fma_f32 v[80:81], v[80:81], v[68:69], v[72:73] op_sel:[1,1,0] op_sel_hi:[0,1,1] neg_lo:[1,0,0]
    v_cvt_pk_bf16_f32 v92, v58, v59
    v_cvt_pk_bf16_f32 v93, v80, v81
    ds_write_addtid_b32 v92 offset:22704
    ds_write_addtid_b32 v93 offset:22960
    v_pk_mul_f32 v[50:51], v[58:59], v[46:47] op_sel:[0,0] op_sel_hi:[1,0]
    v_pk_mul_f32 v[72:73], v[80:81], v[68:69] op_sel:[0,0] op_sel_hi:[1,0]
    v_pk_fma_f32 v[58:59], v[58:59], v[46:47], v[50:51] op_sel:[1,1,0] op_sel_hi:[0,1,1] neg_lo:[1,0,0]
    v_pk_fma_f32 v[80:81], v[80:81], v[68:69], v[72:73] op_sel:[1,1,0] op_sel_hi:[0,1,1] neg_lo:[1,0,0]
    v_cvt_pk_bf16_f32 v94, v58, v59
    v_cvt_pk_bf16_f32 v95, v80, v81
    ds_write_addtid_b32 v94 offset:24768
    ds_write_addtid_b32 v95 offset:25024
    v_pk_mul_f32 v[50:51], v[58:59], v[46:47] op_sel:[0,0] op_sel_hi:[1,0]
    v_pk_mul_f32 v[72:73], v[80:81], v[68:69] op_sel:[0,0] op_sel_hi:[1,0]
    v_pk_fma_f32 v[58:59], v[58:59], v[46:47], v[50:51] op_sel:[1,1,0] op_sel_hi:[0,1,1] neg_lo:[1,0,0]
    v_pk_fma_f32 v[80:81], v[80:81], v[68:69], v[72:73] op_sel:[1,1,0] op_sel_hi:[0,1,1] neg_lo:[1,0,0]
    v_cvt_pk_bf16_f32 v96, v58, v59
    v_cvt_pk_bf16_f32 v97, v80, v81
    ds_write_addtid_b32 v96 offset:26832
    ds_write_addtid_b32 v97 offset:27088
    v_pk_mul_f32 v[50:51], v[58:59], v[46:47] op_sel:[0,0] op_sel_hi:[1,0]
    v_pk_mul_f32 v[72:73], v[80:81], v[68:69] op_sel:[0,0] op_sel_hi:[1,0]
    v_pk_fma_f32 v[58:59], v[58:59], v[46:47], v[50:51] op_sel:[1,1,0] op_sel_hi:[0,1,1] neg_lo:[1,0,0]
    v_pk_fma_f32 v[80:81], v[80:81], v[68:69], v[72:73] op_sel:[1,1,0] op_sel_hi:[0,1,1] neg_lo:[1,0,0]
    v_cvt_pk_bf16_f32 v98, v58, v59
    v_cvt_pk_bf16_f32 v99, v80, v81
    ds_write_addtid_b32 v98 offset:28896
    ds_write_addtid_b32 v99 offset:29152
    v_pk_mul_f32 v[50:51], v[58:59], v[46:47] op_sel:[0,0] op_sel_hi:[1,0]
    v_pk_mul_f32 v[72:73], v[80:81], v[68:69] op_sel:[0,0] op_sel_hi:[1,0]
    v_pk_fma_f32 v[58:59], v[58:59], v[46:47], v[50:51] op_sel:[1,1,0] op_sel_hi:[0,1,1] neg_lo:[1,0,0]
    v_pk_fma_f32 v[80:81], v[80:81], v[68:69], v[72:73] op_sel:[1,1,0] op_sel_hi:[0,1,1] neg_lo:[1,0,0]
    v_cvt_pk_bf16_f32 v92, v58, v59
    v_cvt_pk_bf16_f32 v93, v80, v81
    ds_write_addtid_b32 v92 offset:30960
    ds_write_addtid_b32 v93 offset:31216
    v_pk_mul_f32 v[50:51], v[58:59], v[46:47] op_sel:[0,0] op_sel_hi:[1,0]
    v_pk_mul_f32 v[72:73], v[80:81], v[68:69] op_sel:[0,0] op_sel_hi:[1,0]
    v_pk_fma_f32 v[58:59], v[58:59], v[46:47], v[50:51] op_sel:[1,1,0] op_sel_hi:[0,1,1] neg_lo:[1,0,0]
    v_pk_fma_f32 v[80:81], v[80:81], v[68:69], v[72:73] op_sel:[1,1,0] op_sel_hi:[0,1,1] neg_lo:[1,0,0]
    v_cvt_pk_bf16_f32 v94, v58, v59
    v_cvt_pk_bf16_f32 v95, v80, v81
    ds_write_addtid_b32 v94 offset:33024
    ds_write_addtid_b32 v95 offset:33280
    v_pk_mul_f32 v[50:51], v[58:59], v[46:47] op_sel:[0,0] op_sel_hi:[1,0]
    v_pk_mul_f32 v[72:73], v[80:81], v[68:69] op_sel:[0,0] op_sel_hi:[1,0]
    v_pk_fma_f32 v[58:59], v[58:59], v[46:47], v[50:51] op_sel:[1,1,0] op_sel_hi:[0,1,1] neg_lo:[1,0,0]
    v_pk_fma_f32 v[80:81], v[80:81], v[68:69], v[72:73] op_sel:[1,1,0] op_sel_hi:[0,1,1] neg_lo:[1,0,0]
    v_cvt_pk_bf16_f32 v96, v58, v59
    v_cvt_pk_bf16_f32 v97, v80, v81
    ds_write_addtid_b32 v96 offset:35088
    ds_write_addtid_b32 v97 offset:35344
    v_pk_mul_f32 v[50:51], v[58:59], v[46:47] op_sel:[0,0] op_sel_hi:[1,0]
    v_pk_mul_f32 v[72:73], v[80:81], v[68:69] op_sel:[0,0] op_sel_hi:[1,0]
    v_pk_fma_f32 v[58:59], v[58:59], v[46:47], v[50:51] op_sel:[1,1,0] op_sel_hi:[0,1,1] neg_lo:[1,0,0]
    v_pk_fma_f32 v[80:81], v[80:81], v[68:69], v[72:73] op_sel:[1,1,0] op_sel_hi:[0,1,1] neg_lo:[1,0,0]
    v_cvt_pk_bf16_f32 v98, v58, v59
    v_cvt_pk_bf16_f32 v99, v80, v81
    ds_write_addtid_b32 v98 offset:37152
    ds_write_addtid_b32 v99 offset:37408
    v_pk_mul_f32 v[50:51], v[58:59], v[46:47] op_sel:[0,0] op_sel_hi:[1,0]
    v_pk_mul_f32 v[72:73], v[80:81], v[68:69] op_sel:[0,0] op_sel_hi:[1,0]
    v_pk_fma_f32 v[58:59], v[58:59], v[46:47], v[50:51] op_sel:[1,1,0] op_sel_hi:[0,1,1] neg_lo:[1,0,0]
    v_pk_fma_f32 v[80:81], v[80:81], v[68:69], v[72:73] op_sel:[1,1,0] op_sel_hi:[0,1,1] neg_lo:[1,0,0]
    v_cvt_pk_bf16_f32 v92, v58, v59
    v_cvt_pk_bf16_f32 v93, v80, v81
    ds_write_addtid_b32 v92 offset:39216
    ds_write_addtid_b32 v93 offset:39472
    v_pk_mul_f32 v[50:51], v[58:59], v[46:47] op_sel:[0,0] op_sel_hi:[1,0]
    v_pk_mul_f32 v[72:73], v[80:81], v[68:69] op_sel:[0,0] op_sel_hi:[1,0]
    v_pk_fma_f32 v[58:59], v[58:59], v[46:47], v[50:51] op_sel:[1,1,0] op_sel_hi:[0,1,1] neg_lo:[1,0,0]
    v_pk_fma_f32 v[80:81], v[80:81], v[68:69], v[72:73] op_sel:[1,1,0] op_sel_hi:[0,1,1] neg_lo:[1,0,0]
    v_cvt_pk_bf16_f32 v94, v58, v59
    v_cvt_pk_bf16_f32 v95, v80, v81
    ds_write_addtid_b32 v94 offset:41280
    ds_write_addtid_b32 v95 offset:41536
    v_pk_mul_f32 v[50:51], v[58:59], v[46:47] op_sel:[0,0] op_sel_hi:[1,0]
    v_pk_mul_f32 v[72:73], v[80:81], v[68:69] op_sel:[0,0] op_sel_hi:[1,0]
    v_pk_fma_f32 v[58:59], v[58:59], v[46:47], v[50:51] op_sel:[1,1,0] op_sel_hi:[0,1,1] neg_lo:[1,0,0]
    v_pk_fma_f32 v[80:81], v[80:81], v[68:69], v[72:73] op_sel:[1,1,0] op_sel_hi:[0,1,1] neg_lo:[1,0,0]
    v_cvt_pk_bf16_f32 v96, v58, v59
    v_cvt_pk_bf16_f32 v97, v80, v81
    ds_write_addtid_b32 v96 offset:43344
    ds_write_addtid_b32 v97 offset:43600
    v_pk_mul_f32 v[50:51], v[58:59], v[46:47] op_sel:[0,0] op_sel_hi:[1,0]
    v_pk_mul_f32 v[72:73], v[80:81], v[68:69] op_sel:[0,0] op_sel_hi:[1,0]
    v_pk_fma_f32 v[58:59], v[58:59], v[46:47], v[50:51] op_sel:[1,1,0] op_sel_hi:[0,1,1] neg_lo:[1,0,0]
    v_pk_fma_f32 v[80:81], v[80:81], v[68:69], v[72:73] op_sel:[1,1,0] op_sel_hi:[0,1,1] neg_lo:[1,0,0]
    v_cvt_pk_bf16_f32 v98, v58, v59
    v_cvt_pk_bf16_f32 v99, v80, v81
    ds_write_addtid_b32 v98 offset:45408
    ds_write_addtid_b32 v99 offset:45664
    v_and_b32 v2, 31, v1
    v_mul_u32_u24 v2, 2064, v2
    v_lshrrev_b32 v3, 5, v1
    v_lshlrev_b32 v3, 4, v3
    v_add3_u32 v2, v2, v3, s15
    ds_read_b128 v[24:27], v2 offset:0
    ds_read_b128 v[88:91], v2 offset:43344
    ds_read_b128 v[28:31], v2 offset:32
    ds_read_b128 v[92:95], v2 offset:43376
    ds_read_b128 v[32:35], v2 offset:64
    ds_read_b128 v[96:99], v2 offset:43408
    ds_read_b128 v[36:39], v2 offset:96
    ds_read_b128 v[100:103], v2 offset:43440
    ds_read_b128 v[40:43], v2 offset:128
    ds_read_b128 v[104:107], v2 offset:43472
    ds_read_b128 v[44:47], v2 offset:160
    ds_read_b128 v[108:111], v2 offset:43504
    s_waitcnt lgkmcnt(10)
    v_mfma_f32_32x32x16_bf16 v[152:167], v[24:27], v[88:91], 0
    ds_read_b128 v[48:51], v2 offset:192
    ds_read_b128 v[112:115], v2 offset:43536
    s_waitcnt lgkmcnt(10)
    v_mfma_f32_32x32x16_bf16 v[152:167], v[28:31], v[92:95], v[152:167]
    ds_read_b128 v[52:55], v2 offset:224
    ds_read_b128 v[116:119], v2 offset:43568
    s_waitcnt lgkmcnt(10)
    v_mfma_f32_32x32x16_bf16 v[152:167], v[32:35], v[96:99], v[152:167]
    ds_read_b128 v[56:59], v2 offset:256
    ds_read_b128 v[120:123], v2 offset:43600
    s_waitcnt lgkmcnt(10)
    v_mfma_f32_32x32x16_bf16 v[152:167], v[36:39], v[100:103], v[152:167]
    ds_read_b128 v[60:63], v2 offset:288
    ds_read_b128 v[124:127], v2 offset:43632
    s_waitcnt lgkmcnt(10)
    v_mfma_f32_32x32x16_bf16 v[152:167], v[40:43], v[104:107], v[152:167]
    ds_read_b128 v[64:67], v2 offset:320
    ds_read_b128 v[128:131], v2 offset:43664
    s_waitcnt lgkmcnt(10)
    v_mfma_f32_32x32x16_bf16 v[152:167], v[44:47], v[108:111], v[152:167]
    ds_read_b128 v[68:71], v2 offset:352
    ds_read_b128 v[132:135], v2 offset:43696
    s_waitcnt lgkmcnt(10)
    v_mfma_f32_32x32x16_bf16 v[152:167], v[48:51], v[112:115], v[152:167]
    ds_read_b128 v[72:75], v2 offset:384
    ds_read_b128 v[136:139], v2 offset:43728
    s_waitcnt lgkmcnt(10)
    v_mfma_f32_32x32x16_bf16 v[152:167], v[52:55], v[116:119], v[152:167]
    ds_read_b128 v[76:79], v2 offset:416
    ds_read_b128 v[140:143], v2 offset:43760
    s_waitcnt lgkmcnt(10)
    v_mfma_f32_32x32x16_bf16 v[152:167], v[56:59], v[120:123], v[152:167]
    ds_read_b128 v[80:83], v2 offset:448
    ds_read_b128 v[144:147], v2 offset:43792
    s_waitcnt lgkmcnt(10)
    v_mfma_f32_32x32x16_bf16 v[152:167], v[60:63], v[124:127], v[152:167]
    ds_read_b128 v[84:87], v2 offset:480
    ds_read_b128 v[148:151], v2 offset:43824
    s_waitcnt lgkmcnt(10)
    v_mfma_f32_32x32x16_bf16 v[152:167], v[64:67], v[128:131], v[152:167]
    s_waitcnt lgkmcnt(8)
    v_mfma_f32_32x32x16_bf16 v[152:167], v[68:71], v[132:135], v[152:167]
    s_waitcnt lgkmcnt(6)
    v_mfma_f32_32x32x16_bf16 v[152:167], v[72:75], v[136:139], v[152:167]
    s_waitcnt lgkmcnt(4)
    v_mfma_f32_32x32x16_bf16 v[152:167], v[76:79], v[140:143], v[152:167]
    s_waitcnt lgkmcnt(2)
    v_mfma_f32_32x32x16_bf16 v[152:167], v[80:83], v[144:147], v[152:167]
    s_waitcnt lgkmcnt(0)
    v_mfma_f32_32x32x16_bf16 v[152:167], v[84:87], v[148:151], v[152:167]
    s_mov_b32 m0, s15
    v_lshrrev_b32 v2, 2, v0
    v_mul_u32_u24 v200, 14336, v2
    v_and_b32 v2, 3, v0
    v_lshl_add_u32 v200, v2, 4, v200
    s_lshl_b32 s3, s10, 6
    s_add_u32 s3, s3, 17301504
    v_add_u32 v200, s3, v200
    v_lshlrev_b32 v204, 4, v0
    v_add_u32 v204, 4096, v204
    v_add_u32 v201, 917504, v200
    v_add_u32 v205, 4096, v204
    v_add_u32 v202, 1835008, v200
    v_add_u32 v206, 8192, v204
    v_add_u32 v203, 2752512, v200
    v_add_u32 v207, 12288, v204
    v_bfe_u32 v2, v1, 2, 2
    v_bfe_u32 v3, v1, 3, 1
    v_and_b32 v3, v3, v2
    v_add_u32 v2, v2, v3
    v_mul_u32_u24 v2, 3584, v2
    v_and_b32 v3, 3, v1
    v_mul_u32_u24 v3, 21504, v3
    s_lshl_b32 s3, s10, 4
    s_add_u32 s3, s3, 163840
    v_add3_u32 v6, v2, v3, s3
    ds_write_addtid_b32 v152 offset:0
    ds_write_addtid_b32 v153 offset:2064
    ds_write_addtid_b32 v154 offset:4128
    ds_write_addtid_b32 v155 offset:6192
    ds_write_addtid_b32 v156 offset:8256
    ds_write_addtid_b32 v157 offset:10320
    ds_write_addtid_b32 v158 offset:12384
    ds_write_addtid_b32 v159 offset:14448
    ds_write_addtid_b32 v160 offset:16512
    ds_write_addtid_b32 v161 offset:18576
    ds_write_addtid_b32 v162 offset:20640
    ds_write_addtid_b32 v163 offset:22704
    v_add_u32 v3, v22, v23
    v_add_u32 v4, v3, v23
    v_add_u32 v5, v4, v23
    s_lshl_b32 s3, s6, 2
    s_add_u32 s3, s3, 160928
    v_mov_b32 v2, s3
    v_mov_b32 v24, 1
    ds_write_b32 v2, v24
    s_mov_b32 s64, 0
    v_mov_b32 v2, 160928
lf_3:
    ds_read_b128 v[24:27], v2
    s_waitcnt lgkmcnt(0)
    v_and_b32 v24, v24, v25
    v_and_b32 v26, v26, v27
    v_and_b32 v24, v24, v26
    v_cmp_eq_u32 vcc, 0, v24
    s_cbranch_vccz lfd_4
    s_add_u32 s64, s64, 1
    s_cmp_lt_u32 s64, 400000
    s_cbranch_scc1 lf_3
lfd_4:
    s_cmp_lt_u32 s6, 3
    s_cbranch_scc0 L_nokr
    ds_read_b128 v[24:27], v21 offset:0
    ds_read_b128 v[28:31], v21 offset:512
    ds_read_b128 v[32:35], v21 offset:1024
    ds_read_b128 v[36:39], v21 offset:1536
    s_waitcnt lgkmcnt(2)
    v_add_f32 v24, v24, v28
    ds_write_b32 v22, v24 offset:0
    v_add_f32 v25, v25, v29
    ds_write_b32 v3, v25 offset:0
    v_add_f32 v26, v26, v30
    ds_write_b32 v4, v26 offset:0
    v_add_f32 v27, v27, v31
    ds_write_b32 v5, v27 offset:0
    s_waitcnt lgkmcnt(4)
    v_add_f32 v32, v32, v36
    ds_write_b32 v22, v32 offset:3088
    v_add_f32 v33, v33, v37
    ds_write_b32 v3, v33 offset:3088
    v_add_f32 v34, v34, v38
    ds_write_b32 v4, v34 offset:3088
    v_add_f32 v35, v35, v39
    ds_write_b32 v5, v35 offset:3088
L_nokr:
    s_lshl_b32 s3, s6, 2
    s_add_u32 s3, s3, 160960
    v_mov_b32 v2, s3
    v_mov_b32 v3, 1
    ds_write_b32 v2, v3
    global_load_dwordx4 v[168:171], v200, s[50:51] sc1
    global_load_dwordx4 v[172:175], v201, s[50:51] sc1
    global_load_dwordx4 v[176:179], v202, s[50:51] sc1
    global_load_dwordx4 v[180:183], v203, s[50:51] sc1
    global_load_dwordx4 v[184:187], v204, s[50:51] sc1
    global_load_dwordx4 v[188:191], v205, s[50:51] sc1
    global_load_dwordx4 v[192:195], v206, s[50:51] sc1
    global_load_dwordx4 v[196:199], v207, s[50:51] sc1
    global_load_dwordx4 v[8:11], v6, s[50:51] sc1
    s_mov_b32 s64, 0
    v_mov_b32 v2, 160960
lf_5:
    ds_read_b128 v[24:27], v2
    s_waitcnt lgkmcnt(0)
    v_and_b32 v24, v24, v25
    v_and_b32 v26, v26, v27
    v_and_b32 v24, v24, v26
    v_cmp_eq_u32 vcc, 0, v24
    s_cbranch_vccz lfd_6
    s_add_u32 s64, s64, 1
    s_cmp_lt_u32 s64, 400000
    s_cbranch_scc1 lf_5
lfd_6:
    ds_read_b32 v24, v12 offset:0
    ds_read_b32 v25, v13 offset:0
    ds_read_b32 v26, v14 offset:0
    ds_read_b32 v27, v15 offset:0
    ds_read_b32 v28, v16 offset:0
    ds_read_b32 v29, v17 offset:0
    ds_read_b32 v30, v18 offset:0
    ds_read_b32 v31, v19 offset:0
    ds_read_b32 v32, v20 offset:0
    ds_read_b32 v33, v12 offset:3088
    ds_read_b32 v34, v13 offset:3088
    ds_read_b32 v35, v14 offset:3088
    ds_read_b32 v36, v15 offset:3088
    ds_read_b32 v37, v16 offset:3088
    ds_read_b32 v38, v17 offset:3088
    ds_read_b32 v39, v18 offset:3088
    ds_read_b32 v40, v19 offset:3088
    ds_read_b32 v41, v20 offset:3088
    v_mov_b32 v4, 0
    v_mov_b32 v5, 0
    s_cmp_eq_u32 s6, 3
    s_cbranch_scc0 L_nz1
    v_lshrrev_b32 v3, 2, v1
    v_and_b32 v3, 3, v3
    v_mul_u32_u24 v3, 4160, v3
    v_and_b32 v56, 3, v1
    v_lshl_add_u32 v3, v56, 3, v3
    ds_write_b64 v3, v[4:5] offset:4096
    v_min_u32 v3, 59, v1
    v_lshlrev_b32 v3, 3, v3
    ds_write_b64 v3, v[4:5] offset:16640
    ds_write_b64 v3, v[4:5] offset:21216
L_nz1:
    v_lshlrev_b32 v3, 4, v0
    s_waitcnt lgkmcnt(0)
    v_cvt_pk_bf16_f32 v56, v24, v25
    v_cvt_pk_bf16_f32 v60, v25, v26
    v_cvt_pk_bf16_f32 v57, v26, v27
    v_cvt_pk_bf16_f32 v61, v27, v28
    v_cvt_pk_bf16_f32 v58, v28, v29
    v_cvt_pk_bf16_f32 v62, v29, v30
    v_cvt_pk_bf16_f32 v59, v30, v31
    v_cvt_pk_bf16_f32 v63, v31, v32
    ds_write_b128 v3, v[56:59] offset:0
    ds_write_b128 v3, v[60:63] offset:4160
    v_cvt_pk_bf16_f32 v64, v33, v34
    v_cvt_pk_bf16_f32 v68, v34, v35
    v_cvt_pk_bf16_f32 v65, v35, v36
    v_cvt_pk_bf16_f32 v69, v36, v37
    v_cvt_pk_bf16_f32 v66, v37, v38
    v_cvt_pk_bf16_f32 v70, v38, v39
    v_cvt_pk_bf16_f32 v67, v39, v40
    v_cvt_pk_bf16_f32 v71, v40, v41
    ds_write_b128 v3, v[64:67] offset:8320
    ds_write_b128 v3, v[68:71] offset:12480
    s_mov_b32 s64, 0
    s_branch pskip_9
poll_7:
    global_load_dwordx4 v[168:171], v200, s[50:51] sc1
    global_load_dwordx4 v[172:175], v201, s[50:51] sc1
    global_load_dwordx4 v[176:179], v202, s[50:51] sc1
    global_load_dwordx4 v[180:183], v203, s[50:51] sc1
    global_load_dwordx4 v[184:187], v204, s[50:51] sc1
    global_load_dwordx4 v[188:191], v205, s[50:51] sc1
    global_load_dwordx4 v[192:195], v206, s[50:51] sc1
    global_load_dwordx4 v[196:199], v207, s[50:51] sc1
    global_load_dwordx4 v[8:11], v6, s[50:51] sc1
pskip_9:
    s_waitcnt vmcnt(0)
    v_xor_b32 v169, s7, v169
    v_xor_b32 v171, s7, v171
    v_xor_b32 v173, s7, v173
    v_xor_b32 v175, s7, v175
    v_xor_b32 v177, s7, v177
    v_xor_b32 v179, s7, v179
    v_xor_b32 v181, s7, v181
    v_xor_b32 v183, s7, v183
    v_xor_b32 v185, s7, v185
    v_xor_b32 v187, s7, v187
    v_xor_b32 v189, s7, v189
    v_xor_b32 v191, s7, v191
    v_xor_b32 v193, s7, v193
    v_xor_b32 v195, s7, v195
    v_xor_b32 v197, s7, v197
    v_xor_b32 v199, s7, v199
    v_xor_b32 v9, s7, v9
    v_xor_b32 v11, s7, v11
    v_or3_b32 v169, v169, v171, v173
    v_or3_b32 v169, v169, v175, v177
    v_or3_b32 v169, v169, v179, v181
    v_or3_b32 v169, v169, v183, v185
    v_or3_b32 v169, v169, v187, v189
    v_or3_b32 v169, v169, v191, v193
    v_or3_b32 v169, v169, v195, v197
    v_or3_b32 v169, v169, v199, v9
    v_or_b32 v169, v169, v11
    v_cmp_ne_u32 vcc, 0, v169
    s_cbranch_vccz pdone_8
    s_add_u32 s64, s64, 1
    s_cmp_lt_u32 s64, 20000
    s_sleep 1
    s_cbranch_scc1 poll_7
pdone_8:
    s_lshl_b32 s3, s6, 2
    s_add_u32 s3, s3, 160912
    v_mov_b32 v2, s3
    v_mov_b32 v3, 1
    ds_write_b32 v2, v3
    v_add_f32_dpp v8, v8, v8 quad_perm:[1,0,3,2] row_mask:0xf bank_mask:0xf
    v_add_f32_dpp v10, v10, v10 quad_perm:[1,0,3,2] row_mask:0xf bank_mask:0xf
    s_nop 0
    v_add_f32_dpp v8, v8, v8 quad_perm:[2,3,0,1] row_mask:0xf bank_mask:0xf
    v_add_f32_dpp v10, v10, v10 quad_perm:[2,3,0,1] row_mask:0xf bank_mask:0xf
    v_cvt_pk_bf16_f32 v10, v8, v10
    v_lshlrev_b32 v8, 16, v10
    v_and_b32 v10, 0xffff0000, v10
    v_add_f32 v9, 1.0, v8
    v_add_f32 v11, 1.0, v10
    v_cvt_pk_bf16_f32 v9, v9, v9
    v_and_b32 v9, 0xffff0000, v9
    v_cvt_pk_bf16_f32 v11, v11, v11
    v_and_b32 v11, 0xffff0000, v11
    v_readlane_b32 s8, v8, 0
    v_readlane_b32 s9, v10, 0
    v_readlane_b32 s30, v9, 4
    v_readlane_b32 s31, v11, 4
    v_readlane_b32 s12, v8, 8
    v_readlane_b32 s13, v10, 8
    v_readlane_b32 s28, v9, 12
    v_readlane_b32 s29, v11, 12
    v_lshlrev_b32 v185, 16, v184
    v_and_b32 v184, 0xffff0000, v184
    v_rcp_f32 v184, v184
    v_lshlrev_b32 v187, 16, v186
    v_and_b32 v186, 0xffff0000, v186
    v_rcp_f32 v186, v186
    v_lshlrev_b32 v189, 16, v188
    v_and_b32 v188, 0xffff0000, v188
    v_rcp_f32 v188, v188
    v_lshlrev_b32 v191, 16, v190
    v_and_b32 v190, 0xffff0000, v190
    v_rcp_f32 v190, v190
    v_lshlrev_b32 v193, 16, v192
    v_and_b32 v192, 0xffff0000, v192
    v_rcp_f32 v192, v192
    v_lshlrev_b32 v195, 16, v194
    v_and_b32 v194, 0xffff0000, v194
    v_rcp_f32 v194, v194
    v_lshlrev_b32 v197, 16, v196
    v_and_b32 v196, 0xffff0000, v196
    v_rcp_f32 v196, v196
    v_lshlrev_b32 v199, 16, v198
    v_and_b32 v198, 0xffff0000, v198
    v_rcp_f32 v198, v198
    v_mov_b32 v8, s30
    v_mov_b32 v9, s31
    v_mov_b32 v10, s8
    v_mov_b32 v11, s9
    v_lshlrev_b32 v24, 16, v168
    v_and_b32 v25, 0xffff0000, v168
    v_pk_add_f32 v[24:25], v[24:25], v[184:185] op_sel:[0,1] op_sel_hi:[1,1] neg_lo:[0,1] neg_hi:[0,1]
    v_pk_mul_f32 v[24:25], v[24:25], v[184:185] op_sel:[0,0] op_sel_hi:[1,0]
    v_pk_fma_f32 v[24:25], v[24:25], v[8:9], v[10:11]
    v_lshlrev_b32 v26, 16, v170
    v_and_b32 v27, 0xffff0000, v170
    v_pk_add_f32 v[26:27], v[26:27], v[186:187] op_sel:[0,1] op_sel_hi:[1,1] neg_lo:[0,1] neg_hi:[0,1]
    v_pk_mul_f32 v[26:27], v[26:27], v[186:187] op_sel:[0,0] op_sel_hi:[1,0]
    v_pk_fma_f32 v[26:27], v[26:27], v[8:9], v[10:11]
    v_lshlrev_b32 v28, 16, v172
    v_and_b32 v29, 0xffff0000, v172
    v_pk_add_f32 v[28:29], v[28:29], v[188:189] op_sel:[0,1] op_sel_hi:[1,1] neg_lo:[0,1] neg_hi:[0,1]
    v_pk_mul_f32 v[28:29], v[28:29], v[188:189] op_sel:[0,0] op_sel_hi:[1,0]
    v_pk_fma_f32 v[28:29], v[28:29], v[8:9], v[10:11]
    v_lshlrev_b32 v30, 16, v174
    v_and_b32 v31, 0xffff0000, v174
    v_pk_add_f32 v[30:31], v[30:31], v[190:191] op_sel:[0,1] op_sel_hi:[1,1] neg_lo:[0,1] neg_hi:[0,1]
    v_pk_mul_f32 v[30:31], v[30:31], v[190:191] op_sel:[0,0] op_sel_hi:[1,0]
    v_pk_fma_f32 v[30:31], v[30:31], v[8:9], v[10:11]
    v_lshlrev_b32 v32, 16, v176
    v_and_b32 v33, 0xffff0000, v176
    v_pk_add_f32 v[32:33], v[32:33], v[192:193] op_sel:[0,1] op_sel_hi:[1,1] neg_lo:[0,1] neg_hi:[0,1]
    v_pk_mul_f32 v[32:33], v[32:33], v[192:193] op_sel:[0,0] op_sel_hi:[1,0]
    v_pk_fma_f32 v[32:33], v[32:33], v[8:9], v[10:11]
    v_lshlrev_b32 v34, 16, v178
    v_and_b32 v35, 0xffff0000, v178
    v_pk_add_f32 v[34:35], v[34:35], v[194:195] op_sel:[0,1] op_sel_hi:[1,1] neg_lo:[0,1] neg_hi:[0,1]
    v_pk_mul_f32 v[34:35], v[34:35], v[194:195] op_sel:[0,0] op_sel_hi:[1,0]
    v_pk_fma_f32 v[34:35], v[34:35], v[8:9], v[10:11]
    v_lshlrev_b32 v36, 16, v180
    v_and_b32 v37, 0xffff0000, v180
    v_pk_add_f32 v[36:37], v[36:37], v[196:197] op_sel:[0,1] op_sel_hi:[1,1] neg_lo:[0,1] neg_hi:[0,1]
    v_pk_mul_f32 v[36:37], v[36:37], v[196:197] op_sel:[0,0] op_sel_hi:[1,0]
    v_pk_fma_f32 v[36:37], v[36:37], v[8:9], v[10:11]
    v_lshlrev_b32 v38, 16, v182
    v_and_b32 v39, 0xffff0000, v182
    v_pk_add_f32 v[38:39], v[38:39], v[198:199] op_sel:[0,1] op_sel_hi:[1,1] neg_lo:[0,1] neg_hi:[0,1]
    v_pk_mul_f32 v[38:39], v[38:39], v[198:199] op_sel:[0,0] op_sel_hi:[1,0]
    v_pk_fma_f32 v[38:39], v[38:39], v[8:9], v[10:11]
    v_lshlrev_b32 v3, 2, v0
    v_lshlrev_b32 v4, 3, v0
    v_cvt_pk_bf16_f32 v40, v24, v26
    v_cvt_pk_bf16_f32 v41, v25, v27
    ds_write_b32 v3, v40 offset:17120
    ds_write_b32 v3, v41 offset:21696
    v_mov_b32 v169, v170
    ds_write_b64 v4, v[168:169] offset:25792
    v_cvt_pk_bf16_f32 v42, v28, v30
    v_cvt_pk_bf16_f32 v43, v29, v31
    ds_write_b32 v3, v42 offset:18144
    ds_write_b32 v3, v43 offset:22720
    v_mov_b32 v173, v174
    ds_write_b64 v4, v[172:173] offset:27840
    v_cvt_pk_bf16_f32 v44, v32, v34
    v_cvt_pk_bf16_f32 v45, v33, v35
    ds_write_b32 v3, v44 offset:19168
    ds_write_b32 v3, v45 offset:23744
    v_mov_b32 v177, v178
    ds_write_b64 v4, v[176:177] offset:29888
    v_cvt_pk_bf16_f32 v46, v36, v38
    v_cvt_pk_bf16_f32 v47, v37, v39
    ds_write_b32 v3, v46 offset:20192
    ds_write_b32 v3, v47 offset:24768
    v_mov_b32 v181, v182
    ds_write_b64 v4, v[180:181] offset:31936
    s_lshl_b32 s3, s6, 2
    s_add_u32 s3, s3, 160976
    v_mov_b32 v2, s3
    v_mov_b32 v3, 1
    ds_write_b32 v2, v3
    s_mov_b32 s64, 0
    v_mov_b32 v2, 160976
lf_10:
    ds_read_b128 v[48:51], v2
    s_waitcnt lgkmcnt(0)
    v_and_b32 v48, v48, v49
    v_and_b32 v50, v50, v51
    v_and_b32 v48, v48, v50
    v_cmp_eq_u32 vcc, 0, v48
    s_cbranch_vccz lfd_11
    s_add_u32 s64, s64, 1
    s_cmp_lt_u32 s64, 400000
    s_cbranch_scc1 lf_10
lfd_11:
    s_lshr_b32 s15, s6, 1
    s_and_b32 s3, s6, 1
    v_and_b32 v2, 15, v1
    v_lshrrev_b32 v3, 4, v1
    v_lshrrev_b32 v4, 1, v2
    v_lshlrev_b32 v5, 2, v3
    v_sub_u32 v4, v5, v4
    v_lshlrev_b32 v4, 2, v4
    v_and_b32 v5, 1, v2
    v_mul_u32_u24 v5, 4160, v5
    v_sub_u32 v4, v4, v5
    s_mul_i32 s8, s15, 8320
    s_lshl_b32 s9, s3, 8
    s_sub_u32 s8, s8, s9
    s_add_u32 s8, s8, 7516
    v_add_u32 v168, s8, v4
    v_subrev_u32 v169, 1024, v168
    v_subrev_u32 v170, 2048, v168
    v_subrev_u32 v171, 3072, v168
    v_lshlrev_b32 v4, 5, v2
    v_lshl_add_u32 v4, v3, 4, v4
    s_mul_i32 s8, s15, 4576
    s_sub_u32 s8, s8, s9
    s_add_u32 s8, s8, 16896
    v_add_u32 v6, s8, v4
    ds_read2_b32 v[68:69], v171 offset0:48 offset1:49
    ds_read2_b32 v[70:71], v171 offset0:50 offset1:51
    ds_read_b128 v[104:107], v6 offset:192
    ds_read2_b32 v[64:65], v171 offset0:176 offset1:177
    ds_read2_b32 v[66:67], v171 offset0:178 offset1:179
    ds_read_b128 v[108:111], v6 offset:704
    ds_read2_b32 v[60:61], v170 offset0:48 offset1:49
    ds_read2_b32 v[62:63], v170 offset0:50 offset1:51
    ds_read_b128 v[112:115], v6 offset:1216
    ds_read2_b32 v[56:57], v170 offset0:176 offset1:177
    ds_read2_b32 v[58:59], v170 offset0:178 offset1:179
    ds_read_b128 v[116:119], v6 offset:1728
    ds_read2_b32 v[52:53], v169 offset0:48 offset1:49
    ds_read2_b32 v[54:55], v169 offset0:50 offset1:51
    ds_read_b128 v[120:123], v6 offset:2240
    ds_read2_b32 v[48:49], v169 offset0:176 offset1:177
    ds_read2_b32 v[50:51], v169 offset0:178 offset1:179
    ds_read_b128 v[124:127], v6 offset:2752
    ds_read2_b32 v[44:45], v168 offset0:48 offset1:49
    ds_read2_b32 v[46:47], v168 offset0:50 offset1:51
    ds_read_b128 v[128:131], v6 offset:3264
    ds_read2_b32 v[40:41], v168 offset0:176 offset1:177
    ds_read2_b32 v[42:43], v168 offset0:178 offset1:179
    ds_read_b128 v[132:135], v6 offset:3776
    s_waitcnt lgkmcnt(15)
    v_mfma_f32_16x16x32_bf16 v[36:39], v[68:71], v[104:107], 0
    s_waitcnt lgkmcnt(15)
    v_mfma_f32_16x16x32_bf16 v[32:35], v[64:67], v[104:107], 0
    v_mfma_f32_16x16x32_bf16 v[36:39], v[64:67], v[108:111], v[36:39]
    s_waitcnt lgkmcnt(15)
    v_mfma_f32_16x16x32_bf16 v[28:31], v[60:63], v[104:107], 0
    v_mfma_f32_16x16x32_bf16 v[32:35], v[60:63], v[108:111], v[32:35]
    v_mfma_f32_16x16x32_bf16 v[36:39], v[60:63], v[112:115], v[36:39]
    s_waitcnt lgkmcnt(12)
    v_mfma_f32_16x16x32_bf16 v[24:27], v[56:59], v[104:107], 0
    v_mfma_f32_16x16x32_bf16 v[28:31], v[56:59], v[108:111], v[28:31]
    v_mfma_f32_16x16x32_bf16 v[32:35], v[56:59], v[112:115], v[32:35]
    v_mfma_f32_16x16x32_bf16 v[36:39], v[56:59], v[116:119], v[36:39]
    s_waitcnt lgkmcnt(9)
    v_mfma_f32_16x16x32_bf16 v[20:23], v[52:55], v[104:107], 0
    ds_read2_b32 v[100:101], v171 offset0:32 offset1:33
    v_mfma_f32_16x16x32_bf16 v[24:27], v[52:55], v[108:111], v[24:27]
    ds_read2_b32 v[102:103], v171 offset0:34 offset1:35
    v_mfma_f32_16x16x32_bf16 v[28:31], v[52:55], v[112:115], v[28:31]
    ds_read_b128 v[136:139], v6 offset:128
    v_mfma_f32_16x16x32_bf16 v[32:35], v[52:55], v[116:119], v[32:35]
    ds_read2_b32 v[96:97], v171 offset0:160 offset1:161
    v_mfma_f32_16x16x32_bf16 v[36:39], v[52:55], v[120:123], v[36:39]
    ds_read2_b32 v[98:99], v171 offset0:162 offset1:163
    s_waitcnt lgkmcnt(11)
    v_mfma_f32_16x16x32_bf16 v[16:19], v[48:51], v[104:107], 0
    ds_read_b128 v[140:143], v6 offset:640
    v_mfma_f32_16x16x32_bf16 v[20:23], v[48:51], v[108:111], v[20:23]
    ds_read2_b32 v[92:93], v170 offset0:32 offset1:33
    v_mfma_f32_16x16x32_bf16 v[24:27], v[48:51], v[112:115], v[24:27]
    ds_read2_b32 v[94:95], v170 offset0:34 offset1:35
    v_mfma_f32_16x16x32_bf16 v[28:31], v[48:51], v[116:119], v[28:31]
    ds_read_b128 v[144:147], v6 offset:1152
    v_mfma_f32_16x16x32_bf16 v[32:35], v[48:51], v[120:123], v[32:35]
    ds_read2_b32 v[88:89], v170 offset0:160 offset1:161
    v_mfma_f32_16x16x32_bf16 v[36:39], v[48:51], v[124:127], v[36:39]
    ds_read2_b32 v[90:91], v170 offset0:162 offset1:163
    s_waitcnt lgkmcnt(14)
    v_mfma_f32_16x16x32_bf16 v[12:15], v[44:47], v[104:107], 0
    ds_read_b128 v[148:151], v6 offset:1664
    v_mfma_f32_16x16x32_bf16 v[16:19], v[44:47], v[108:111], v[16:19]
    ds_read2_b32 v[84:85], v169 offset0:32 offset1:33
    v_mfma_f32_16x16x32_bf16 v[20:23], v[44:47], v[112:115], v[20:23]
    ds_read2_b32 v[86:87], v169 offset0:34 offset1:35
    v_mfma_f32_16x16x32_bf16 v[24:27], v[44:47], v[116:119], v[24:27]
    ds_read_b128 v[152:155], v6 offset:2176
    v_mfma_f32_16x16x32_bf16 v[28:31], v[44:47], v[120:123], v[28:31]
    ds_read2_b32 v[80:81], v169 offset0:160 offset1:161
    v_mfma_f32_16x16x32_bf16 v[32:35], v[44:47], v[124:127], v[32:35]
    ds_read2_b32 v[82:83], v169 offset0:162 offset1:163
    v_mfma_f32_16x16x32_bf16 v[36:39], v[44:47], v[128:131], v[36:39]
    ds_read_b128 v[156:159], v6 offset:2688
    s_waitcnt lgkmcnt(15)
    v_mfma_f32_16x16x32_bf16 v[8:11], v[40:43], v[104:107], 0
    ds_read2_b32 v[76:77], v168 offset0:32 offset1:33
    v_mfma_f32_16x16x32_bf16 v[12:15], v[40:43], v[108:111], v[12:15]
    ds_read2_b32 v[78:79], v168 offset0:34 offset1:35
    v_mfma_f32_16x16x32_bf16 v[16:19], v[40:43], v[112:115], v[16:19]
    ds_read_b128 v[160:163], v6 offset:3200
    v_mfma_f32_16x16x32_bf16 v[20:23], v[40:43], v[116:119], v[20:23]
    ds_read2_b32 v[72:73], v168 offset0:160 offset1:161
    v_mfma_f32_16x16x32_bf16 v[24:27], v[40:43], v[120:123], v[24:27]
    ds_read2_b32 v[74:75], v168 offset0:162 offset1:163
    v_mfma_f32_16x16x32_bf16 v[28:31], v[40:43], v[124:127], v[28:31]
    ds_read_b128 v[164:167], v6 offset:3712
    v_mfma_f32_16x16x32_bf16 v[32:35], v[40:43], v[128:131], v[32:35]
    v_mfma_f32_16x16x32_bf16 v[36:39], v[40:43], v[132:135], v[36:39]
    s_waitcnt lgkmcnt(0)
    v_mfma_f32_16x16x32_bf16 v[36:39], v[100:103], v[136:139], v[36:39]
    ds_read2_b32 v[68:69], v171 offset0:16 offset1:17
    v_mfma_f32_16x16x32_bf16 v[32:35], v[96:99], v[136:139], v[32:35]
    ds_read2_b32 v[70:71], v171 offset0:18 offset1:19
    v_mfma_f32_16x16x32_bf16 v[36:39], v[96:99], v[140:143], v[36:39]
    ds_read_b128 v[104:107], v6 offset:64
    v_mfma_f32_16x16x32_bf16 v[28:31], v[92:95], v[136:139], v[28:31]
    ds_read2_b32 v[64:65], v171 offset0:144 offset1:145
    v_mfma_f32_16x16x32_bf16 v[32:35], v[92:95], v[140:143], v[32:35]
    ds_read2_b32 v[66:67], v171 offset0:146 offset1:147
    v_mfma_f32_16x16x32_bf16 v[36:39], v[92:95], v[144:147], v[36:39]
    ds_read_b128 v[108:111], v6 offset:576
    v_mfma_f32_16x16x32_bf16 v[24:27], v[88:91], v[136:139], v[24:27]
    ds_read2_b32 v[60:61], v170 offset0:16 offset1:17
    v_mfma_f32_16x16x32_bf16 v[28:31], v[88:91], v[140:143], v[28:31]
    ds_read2_b32 v[62:63], v170 offset0:18 offset1:19
    v_mfma_f32_16x16x32_bf16 v[32:35], v[88:91], v[144:147], v[32:35]
    ds_read_b128 v[112:115], v6 offset:1088
    v_mfma_f32_16x16x32_bf16 v[36:39], v[88:91], v[148:151], v[36:39]
    ds_read2_b32 v[56:57], v170 offset0:144 offset1:145
    v_mfma_f32_16x16x32_bf16 v[20:23], v[84:87], v[136:139], v[20:23]
    ds_read2_b32 v[58:59], v170 offset0:146 offset1:147
    v_mfma_f32_16x16x32_bf16 v[24:27], v[84:87], v[140:143], v[24:27]
    ds_read_b128 v[116:119], v6 offset:1600
    v_mfma_f32_16x16x32_bf16 v[28:31], v[84:87], v[144:147], v[28:31]
    ds_read2_b32 v[52:53], v169 offset0:16 offset1:17
    v_mfma_f32_16x16x32_bf16 v[32:35], v[84:87], v[148:151], v[32:35]
    ds_read2_b32 v[54:55], v169 offset0:18 offset1:19
    v_mfma_f32_16x16x32_bf16 v[36:39], v[84:87], v[152:155], v[36:39]
    ds_read_b128 v[120:123], v6 offset:2112
    v_mfma_f32_16x16x32_bf16 v[16:19], v[80:83], v[136:139], v[16:19]
    ds_read2_b32 v[48:49], v169 offset0:144 offset1:145
    v_mfma_f32_16x16x32_bf16 v[20:23], v[80:83], v[140:143], v[20:23]
    ds_read2_b32 v[50:51], v169 offset0:146 offset1:147
    v_mfma_f32_16x16x32_bf16 v[24:27], v[80:83], v[144:147], v[24:27]
    ds_read_b128 v[124:127], v6 offset:2624
    v_mfma_f32_16x16x32_bf16 v[28:31], v[80:83], v[148:151], v[28:31]
    ds_read2_b32 v[44:45], v168 offset0:16 offset1:17
    v_mfma_f32_16x16x32_bf16 v[32:35], v[80:83], v[152:155], v[32:35]
    ds_read2_b32 v[46:47], v168 offset0:18 offset1:19
    v_mfma_f32_16x16x32_bf16 v[36:39], v[80:83], v[156:159], v[36:39]
    ds_read_b128 v[128:131], v6 offset:3136
    v_mfma_f32_16x16x32_bf16 v[12:15], v[76:79], v[136:139], v[12:15]
    ds_read2_b32 v[40:41], v168 offset0:144 offset1:145
    v_mfma_f32_16x16x32_bf16 v[16:19], v[76:79], v[140:143], v[16:19]
    ds_read2_b32 v[42:43], v168 offset0:146 offset1:147
    v_mfma_f32_16x16x32_bf16 v[20:23], v[76:79], v[144:147], v[20:23]
    ds_read_b128 v[132:135], v6 offset:3648
    v_mfma_f32_16x16x32_bf16 v[24:27], v[76:79], v[148:151], v[24:27]
    v_mfma_f32_16x16x32_bf16 v[28:31], v[76:79], v[152:155], v[28:31]
    v_mfma_f32_16x16x32_bf16 v[32:35], v[76:79], v[156:159], v[32:35]
    v_mfma_f32_16x16x32_bf16 v[36:39], v[76:79], v[160:163], v[36:39]
    v_mfma_f32_16x16x32_bf16 v[8:11], v[72:75], v[136:139], v[8:11]
    v_mfma_f32_16x16x32_bf16 v[12:15], v[72:75], v[140:143], v[12:15]
    v_mfma_f32_16x16x32_bf16 v[16:19], v[72:75], v[144:147], v[16:19]
    v_mfma_f32_16x16x32_bf16 v[20:23], v[72:75], v[148:151], v[20:23]
    v_mfma_f32_16x16x32_bf16 v[24:27], v[72:75], v[152:155], v[24:27]
    v_mfma_f32_16x16x32_bf16 v[28:31], v[72:75], v[156:159], v[28:31]
    v_mfma_f32_16x16x32_bf16 v[32:35], v[72:75], v[160:163], v[32:35]
    v_mfma_f32_16x16x32_bf16 v[36:39], v[72:75], v[164:167], v[36:39]
    s_waitcnt lgkmcnt(0)
    v_mfma_f32_16x16x32_bf16 v[36:39], v[68:71], v[104:107], v[36:39]
    ds_read2_b32 v[100:101], v171 offset0:0 offset1:1
    v_mfma_f32_16x16x32_bf16 v[32:35], v[64:67], v[104:107], v[32:35]
    ds_read2_b32 v[102:103], v171 offset0:2 offset1:3
    v_mfma_f32_16x16x32_bf16 v[36:39], v[64:67], v[108:111], v[36:39]
    ds_read_b128 v[136:139], v6 offset:0
    v_mfma_f32_16x16x32_bf16 v[28:31], v[60:63], v[104:107], v[28:31]
    ds_read2_b32 v[96:97], v171 offset0:128 offset1:129
    v_mfma_f32_16x16x32_bf16 v[32:35], v[60:63], v[108:111], v[32:35]
    ds_read2_b32 v[98:99], v171 offset0:130 offset1:131
    v_mfma_f32_16x16x32_bf16 v[36:39], v[60:63], v[112:115], v[36:39]
    ds_read_b128 v[140:143], v6 offset:512
    v_mfma_f32_16x16x32_bf16 v[24:27], v[56:59], v[104:107], v[24:27]
    ds_read2_b32 v[92:93], v170 offset0:0 offset1:1
    v_mfma_f32_16x16x32_bf16 v[28:31], v[56:59], v[108:111], v[28:31]
    ds_read2_b32 v[94:95], v170 offset0:2 offset1:3
    v_mfma_f32_16x16x32_bf16 v[32:35], v[56:59], v[112:115], v[32:35]
    ds_read_b128 v[144:147], v6 offset:1024
    v_mfma_f32_16x16x32_bf16 v[36:39], v[56:59], v[116:119], v[36:39]
    ds_read2_b32 v[88:89], v170 offset0:128 offset1:129
    v_mfma_f32_16x16x32_bf16 v[20:23], v[52:55], v[104:107], v[20:23]
    ds_read2_b32 v[90:91], v170 offset0:130 offset1:131
    v_mfma_f32_16x16x32_bf16 v[24:27], v[52:55], v[108:111], v[24:27]
    ds_read_b128 v[148:151], v6 offset:1536
    v_mfma_f32_16x16x32_bf16 v[28:31], v[52:55], v[112:115], v[28:31]
    ds_read2_b32 v[84:85], v169 offset0:0 offset1:1
    v_mfma_f32_16x16x32_bf16 v[32:35], v[52:55], v[116:119], v[32:35]
    ds_read2_b32 v[86:87], v169 offset0:2 offset1:3
    v_mfma_f32_16x16x32_bf16 v[36:39], v[52:55], v[120:123], v[36:39]
    ds_read_b128 v[152:155], v6 offset:2048
    v_mfma_f32_16x16x32_bf16 v[16:19], v[48:51], v[104:107], v[16:19]
    ds_read2_b32 v[80:81], v169 offset0:128 offset1:129
    v_mfma_f32_16x16x32_bf16 v[20:23], v[48:51], v[108:111], v[20:23]
    ds_read2_b32 v[82:83], v169 offset0:130 offset1:131
    v_mfma_f32_16x16x32_bf16 v[24:27], v[48:51], v[112:115], v[24:27]
    ds_read_b128 v[156:159], v6 offset:2560
    v_mfma_f32_16x16x32_bf16 v[28:31], v[48:51], v[116:119], v[28:31]
    ds_read2_b32 v[76:77], v168 offset0:0 offset1:1
    v_mfma_f32_16x16x32_bf16 v[32:35], v[48:51], v[120:123], v[32:35]
    ds_read2_b32 v[78:79], v168 offset0:2 offset1:3
    v_mfma_f32_16x16x32_bf16 v[36:39], v[48:51], v[124:127], v[36:39]
    ds_read_b128 v[160:163], v6 offset:3072
    v_mfma_f32_16x16x32_bf16 v[12:15], v[44:47], v[104:107], v[12:15]
    ds_read2_b32 v[72:73], v168 offset0:128 offset1:129
    v_mfma_f32_16x16x32_bf16 v[16:19], v[44:47], v[108:111], v[16:19]
    ds_read2_b32 v[74:75], v168 offset0:130 offset1:131
    v_mfma_f32_16x16x32_bf16 v[20:23], v[44:47], v[112:115], v[20:23]
    ds_read_b128 v[164:167], v6 offset:3584
    v_mfma_f32_16x16x32_bf16 v[24:27], v[44:47], v[116:119], v[24:27]
    v_mfma_f32_16x16x32_bf16 v[28:31], v[44:47], v[120:123], v[28:31]
    v_mfma_f32_16x16x32_bf16 v[32:35], v[44:47], v[124:127], v[32:35]
    v_mfma_f32_16x16x32_bf16 v[36:39], v[44:47], v[128:131], v[36:39]
    v_mfma_f32_16x16x32_bf16 v[8:11], v[40:43], v[104:107], v[8:11]
    v_mfma_f32_16x16x32_bf16 v[12:15], v[40:43], v[108:111], v[12:15]
    v_mfma_f32_16x16x32_bf16 v[16:19], v[40:43], v[112:115], v[16:19]
    v_mfma_f32_16x16x32_bf16 v[20:23], v[40:43], v[116:119], v[20:23]
    v_mfma_f32_16x16x32_bf16 v[24:27], v[40:43], v[120:123], v[24:27]
    v_mfma_f32_16x16x32_bf16 v[28:31], v[40:43], v[124:127], v[28:31]
    v_mfma_f32_16x16x32_bf16 v[32:35], v[40:43], v[128:131], v[32:35]
    v_mfma_f32_16x16x32_bf16 v[36:39], v[40:43], v[132:135], v[36:39]
    v_mov_b32 v4, 161024
    v_mov_b32 v5, 1
    ds_write_b32 v4, v5
    s_waitcnt lgkmcnt(0)
    v_mfma_f32_16x16x32_bf16 v[36:39], v[100:103], v[136:139], v[36:39]
    v_mfma_f32_16x16x32_bf16 v[32:35], v[96:99], v[136:139], v[32:35]
    v_mfma_f32_16x16x32_bf16 v[36:39], v[96:99], v[140:143], v[36:39]
    v_mfma_f32_16x16x32_bf16 v[28:31], v[92:95], v[136:139], v[28:31]
    v_mfma_f32_16x16x32_bf16 v[32:35], v[92:95], v[140:143], v[32:35]
    v_mfma_f32_16x16x32_bf16 v[36:39], v[92:95], v[144:147], v[36:39]
    v_mfma_f32_16x16x32_bf16 v[24:27], v[88:91], v[136:139], v[24:27]
    v_mfma_f32_16x16x32_bf16 v[28:31], v[88:91], v[140:143], v[28:31]
    v_mfma_f32_16x16x32_bf16 v[32:35], v[88:91], v[144:147], v[32:35]
    v_mfma_f32_16x16x32_bf16 v[36:39], v[88:91], v[148:151], v[36:39]
    v_mfma_f32_16x16x32_bf16 v[20:23], v[84:87], v[136:139], v[20:23]
    v_mfma_f32_16x16x32_bf16 v[24:27], v[84:87], v[140:143], v[24:27]
    v_mfma_f32_16x16x32_bf16 v[28:31], v[84:87], v[144:147], v[28:31]
    v_mfma_f32_16x16x32_bf16 v[32:35], v[84:87], v[148:151], v[32:35]
    v_mfma_f32_16x16x32_bf16 v[36:39], v[84:87], v[152:155], v[36:39]
    v_mfma_f32_16x16x32_bf16 v[16:19], v[80:83], v[136:139], v[16:19]
    v_mfma_f32_16x16x32_bf16 v[20:23], v[80:83], v[140:143], v[20:23]
    v_mfma_f32_16x16x32_bf16 v[24:27], v[80:83], v[144:147], v[24:27]
    v_mfma_f32_16x16x32_bf16 v[28:31], v[80:83], v[148:151], v[28:31]
    v_mfma_f32_16x16x32_bf16 v[32:35], v[80:83], v[152:155], v[32:35]
    v_mfma_f32_16x16x32_bf16 v[36:39], v[80:83], v[156:159], v[36:39]
    v_mfma_f32_16x16x32_bf16 v[12:15], v[76:79], v[136:139], v[12:15]
    v_mfma_f32_16x16x32_bf16 v[16:19], v[76:79], v[140:143], v[16:19]
    v_mfma_f32_16x16x32_bf16 v[20:23], v[76:79], v[144:147], v[20:23]
    v_mfma_f32_16x16x32_bf16 v[24:27], v[76:79], v[148:151], v[24:27]
    v_mfma_f32_16x16x32_bf16 v[28:31], v[76:79], v[152:155], v[28:31]
    v_mfma_f32_16x16x32_bf16 v[32:35], v[76:79], v[156:159], v[32:35]
    v_mfma_f32_16x16x32_bf16 v[36:39], v[76:79], v[160:163], v[36:39]
    v_mfma_f32_16x16x32_bf16 v[8:11], v[72:75], v[136:139], v[8:11]
    v_mfma_f32_16x16x32_bf16 v[12:15], v[72:75], v[140:143], v[12:15]
    v_mfma_f32_16x16x32_bf16 v[16:19], v[72:75], v[144:147], v[16:19]
    v_mfma_f32_16x16x32_bf16 v[20:23], v[72:75], v[148:151], v[20:23]
    v_mfma_f32_16x16x32_bf16 v[24:27], v[72:75], v[152:155], v[24:27]
    v_mfma_f32_16x16x32_bf16 v[28:31], v[72:75], v[156:159], v[28:31]
    v_mfma_f32_16x16x32_bf16 v[32:35], v[72:75], v[160:163], v[32:35]
    v_mfma_f32_16x16x32_bf16 v[36:39], v[72:75], v[164:167], v[36:39]
    v_lshlrev_b32 v6, 4, v2
    v_lshl_add_u32 v6, v3, 2, v6
    s_lshl_b32 s8, s6, 9
    v_add_u32 v6, s8, v6
    v_lshlrev_b32 v4, 1, v6
    v_lshlrev_b32 v6, 2, v6
    ds_read_b128 v[40:43], v6 offset:25792
    ds_read_b64 v[48:49], v4 offset:17120
    ds_read_b64 v[50:51], v4 offset:21696
    ds_read_b128 v[44:47], v6 offset:26816
    ds_read_b64 v[52:53], v4 offset:17632
    ds_read_b64 v[54:55], v4 offset:22208
    s_lshl_b32 s8, s6, 13
    v_lshl_add_u32 v92, v1, 4, s8
    ds_write_b128 v92, v[8:11] offset:34048
    ds_write_b128 v92, v[12:15] offset:35072
    ds_write_b128 v92, v[16:19] offset:36096
    ds_write_b128 v92, v[20:23] offset:37120
    ds_write_b128 v92, v[24:27] offset:38144
    ds_write_b128 v92, v[28:31] offset:39168
    ds_write_b128 v92, v[32:35] offset:40192
    ds_write_b128 v92, v[36:39] offset:41216
    s_lshl_b32 s3, s6, 2
    s_add_u32 s3, s3, 160768
    v_mov_b32 v4, s3
    v_mov_b32 v5, 1
    ds_write_b32 v4, v5
    s_lshl_b32 s8, s14, 16
    s_and_b32 s9, s14, 0xffff0000
    s_lshl_b32 s15, s10, 13
    s_add_u32 s15, s15, 1048576
    v_add_u32 v6, s15, v6
    v_add_u32 v7, 1835008, v6
    s_lshl_b32 s3, s6, 11
    v_lshl_add_u32 v92, v1, 4, s3
    s_waitcnt lgkmcnt(9)
    v_mov_b32 v4, s8
    v_mov_b32 v5, s9
    v_mul_f32 v4, s12, v4
    v_mul_f32 v5, s13, v5
    v_lshlrev_b32 v96, 16, v40
    v_and_b32 v100, 0xffff0000, v40
    v_lshlrev_b32 v88, 16, v48
    v_lshlrev_b32 v89, 16, v50
    v_fmac_f32 v96, v4, v88
    v_fmac_f32 v100, v5, v89
    v_lshlrev_b32 v97, 16, v41
    v_and_b32 v101, 0xffff0000, v41
    v_and_b32 v88, 0xffff0000, v48
    v_and_b32 v89, 0xffff0000, v50
    v_fmac_f32 v97, v4, v88
    v_fmac_f32 v101, v5, v89
    v_lshlrev_b32 v98, 16, v42
    v_and_b32 v102, 0xffff0000, v42
    v_lshlrev_b32 v88, 16, v49
    v_lshlrev_b32 v89, 16, v51
    v_fmac_f32 v98, v4, v88
    v_fmac_f32 v102, v5, v89
    v_lshlrev_b32 v99, 16, v43
    v_and_b32 v103, 0xffff0000, v43
    v_and_b32 v88, 0xffff0000, v49
    v_and_b32 v89, 0xffff0000, v51
    v_fmac_f32 v99, v4, v88
    v_fmac_f32 v103, v5, v89
    v_lshlrev_b32 v104, 16, v44
    v_and_b32 v108, 0xffff0000, v44
    v_lshlrev_b32 v88, 16, v52
    v_lshlrev_b32 v89, 16, v54
    v_fmac_f32 v104, v4, v88
    v_fmac_f32 v108, v5, v89
    v_lshlrev_b32 v105, 16, v45
    v_and_b32 v109, 0xffff0000, v45
    v_and_b32 v88, 0xffff0000, v52
    v_and_b32 v89, 0xffff0000, v54
    v_fmac_f32 v105, v4, v88
    v_fmac_f32 v109, v5, v89
    v_lshlrev_b32 v106, 16, v46
    v_and_b32 v110, 0xffff0000, v46
    v_lshlrev_b32 v88, 16, v53
    v_lshlrev_b32 v89, 16, v55
    v_fmac_f32 v106, v4, v88
    v_fmac_f32 v110, v5, v89
    v_lshlrev_b32 v107, 16, v47
    v_and_b32 v111, 0xffff0000, v47
    v_and_b32 v88, 0xffff0000, v53
    v_and_b32 v89, 0xffff0000, v55
    v_fmac_f32 v107, v4, v88
    v_fmac_f32 v111, v5, v89
    s_mov_b32 s64, 0
    v_mov_b32 v5, 160768
lf_12:
    ds_read_b128 v[88:91], v5
    s_waitcnt lgkmcnt(0)
    v_and_b32 v88, v88, v89
    v_and_b32 v90, v90, v91
    v_and_b32 v88, v88, v90
    v_cmp_eq_u32 vcc, 0, v88
    s_cbranch_vccz lfd_13
    s_add_u32 s64, s64, 1
    s_cmp_lt_u32 s64, 400000
    s_cbranch_scc1 lf_12
lfd_13:
    ds_read_b128 v[56:59], v92 offset:34048
    ds_read_b128 v[60:63], v92 offset:42240
    ds_read_b128 v[64:67], v92 offset:50432
    ds_read_b128 v[68:71], v92 offset:58624
    ds_read_b128 v[72:75], v92 offset:35072
    ds_read_b128 v[76:79], v92 offset:43264
    ds_read_b128 v[80:83], v92 offset:51456
    ds_read_b128 v[84:87], v92 offset:59648
    s_waitcnt lgkmcnt(4)
    v_add_f32 v56, v56, v60
    v_add_f32 v64, v64, v68
    v_add_f32 v57, v57, v61
    v_add_f32 v65, v65, v69
    v_add_f32 v58, v58, v62
    v_add_f32 v66, v66, v70
    v_add_f32 v59, v59, v63
    v_add_f32 v67, v67, v71
    v_fmac_f32 v96, s12, v56
    v_fmac_f32 v100, s13, v64
    v_fmac_f32 v97, s12, v57
    v_fmac_f32 v101, s13, v65
    v_fmac_f32 v98, s12, v58
    v_fmac_f32 v102, s13, v66
    v_fmac_f32 v99, s12, v59
    v_fmac_f32 v103, s13, v67
    v_cvt_pk_bf16_f32 v56, v96, v100
    v_cvt_pk_bf16_f32 v57, v97, v101
    v_cvt_pk_bf16_f32 v58, v98, v102
    v_cvt_pk_bf16_f32 v59, v99, v103
    v_lshlrev_b32 v96, 16, v56
    v_and_b32 v100, 0xffff0000, v56
    v_mul_f32 v96, s28, v96
    v_mul_f32 v100, s29, v100
    v_lshlrev_b32 v97, 16, v57
    v_and_b32 v101, 0xffff0000, v57
    v_mul_f32 v97, s28, v97
    v_mul_f32 v101, s29, v101
    v_lshlrev_b32 v98, 16, v58
    v_and_b32 v102, 0xffff0000, v58
    v_mul_f32 v98, s28, v98
    v_mul_f32 v102, s29, v102
    v_lshlrev_b32 v99, 16, v59
    v_and_b32 v103, 0xffff0000, v59
    v_mul_f32 v99, s28, v99
    v_mul_f32 v103, s29, v103
    v_cvt_pk_bf16_f32 v60, v96, v100
    v_cvt_pk_bf16_f32 v61, v97, v101
    v_cvt_pk_bf16_f32 v62, v98, v102
    v_cvt_pk_bf16_f32 v63, v99, v103
    global_store_dwordx4 v7, v[60:63], s[50:51] offset:0 sc1
    global_store_dwordx4 v6, v[56:59], s[50:51] offset:0 sc1
    s_waitcnt lgkmcnt(0)
    v_add_f32 v72, v72, v76
    v_add_f32 v80, v80, v84
    v_add_f32 v73, v73, v77
    v_add_f32 v81, v81, v85
    v_add_f32 v74, v74, v78
    v_add_f32 v82, v82, v86
    v_add_f32 v75, v75, v79
    v_add_f32 v83, v83, v87
    v_fmac_f32 v104, s12, v72
    v_fmac_f32 v108, s13, v80
    v_fmac_f32 v105, s12, v73
    v_fmac_f32 v109, s13, v81
    v_fmac_f32 v106, s12, v74
    v_fmac_f32 v110, s13, v82
    v_fmac_f32 v107, s12, v75
    v_fmac_f32 v111, s13, v83
    v_cvt_pk_bf16_f32 v72, v104, v108
    v_cvt_pk_bf16_f32 v73, v105, v109
    v_cvt_pk_bf16_f32 v74, v106, v110
    v_cvt_pk_bf16_f32 v75, v107, v111
    v_lshlrev_b32 v104, 16, v72
    v_and_b32 v108, 0xffff0000, v72
    v_mul_f32 v104, s28, v104
    v_mul_f32 v108, s29, v108
    v_lshlrev_b32 v105, 16, v73
    v_and_b32 v109, 0xffff0000, v73
    v_mul_f32 v105, s28, v105
    v_mul_f32 v109, s29, v109
    v_lshlrev_b32 v106, 16, v74
    v_and_b32 v110, 0xffff0000, v74
    v_mul_f32 v106, s28, v106
    v_mul_f32 v110, s29, v110
    v_lshlrev_b32 v107, 16, v75
    v_and_b32 v111, 0xffff0000, v75
    v_mul_f32 v107, s28, v107
    v_mul_f32 v111, s29, v111
    v_cvt_pk_bf16_f32 v76, v104, v108
    v_cvt_pk_bf16_f32 v77, v105, v109
    v_cvt_pk_bf16_f32 v78, v106, v110
    v_cvt_pk_bf16_f32 v79, v107, v111
    global_store_dwordx4 v7, v[76:79], s[50:51] offset:1024 sc1
    global_store_dwordx4 v6, v[72:75], s[50:51] offset:1024 sc1
    s_mul_i32 s3, s6, 224
    s_add_u32 s3, s3, s10
    s_lshl_b32 s3, s3, 7
    s_add_u32 s3, s3, 786432
    v_mov_b32 v2, s3
    v_mov_b32 v3, s7
    s_waitcnt vmcnt(0)
    s_mov_b64 exec, 1
    global_store_dword v2, v3, s[50:51] sc1
    s_mov_b64 exec, -1
L_g0b:
    s_barrier
    v_lshrrev_b32 v2, 5, v1
    v_and_b32 v3, 31, v1
    v_lshlrev_b32 v232, 15, v2
    v_lshl_add_u32 v232, v3, 2, v232
    s_lshl_b32 s15, s16, 9
    s_lshl_b32 s3, s6, 7
    s_add_u32 s15, s15, s3
    v_add_u32 v232, s15, v232
    v_add_u32 v233, 8192, v232
    v_add_u32 v234, 16384, v232
    v_add_u32 v235, 24576, v232
    s_lshl_b32 s15, s15, 2
    s_add_u32 s15, s15, 32768
    v_lshl_add_u32 v247, v3, 4, s15
    v_bfe_u32 v3, v1, 4, 1
    v_mul_u32_u24 v6, 14592, v3
    v_bfe_u32 v3, v1, 2, 2
    v_mul_u32_u24 v3, 3648, v3
    v_and_b32 v4, 3, v1
    v_lshlrev_b32 v4, 4, v4
    v_add3_u32 v6, v6, v3, v4
    v_lshl_add_u32 v6, v2, 6, v6
    v_add_u32 v7, 66816, v6
    v_lshlrev_b32 v246, 4, v2
    v_add_u32 v246, 157952, v246
    s_lshl_b32 s15, s16, 2
    s_add_u32 s15, s15, s6
    s_mul_i32 s15, s15, 112
    s_mul_i32 s3, s17, 7
    s_add_u32 s15, s15, s3
    s_lshl_b32 s15, s15, 10
    s_add_u32 s15, s15, 9830400
    v_lshl_add_u32 v244, v1, 4, s15
    v_add_u32 v245, 4096, v244
    s_lshl_b32 s15, s16, 4
    s_add_u32 s15, s15, s17
    s_lshl_b32 s15, s15, 2
    s_add_u32 s15, s15, s6
    s_lshl_b32 s15, s15, 7
    s_add_u32 s62, s15, 262144
    s_lshl_b32 s63, s7, 3
    s_lshl_b32 s61, s6, 2
    s_add_u32 s61, s61, 160848
    s_barrier
    s_mov_b32 s15, 0
    buffer_load_dword v8, v232, s[52:55], s15 offen sc1
    buffer_load_dword v9, v233, s[52:55], s15 offen sc1
    buffer_load_dword v10, v234, s[52:55], s15 offen sc1
    buffer_load_dword v11, v235, s[52:55], s15 offen sc1
    s_mov_b32 s15, 65536
    buffer_load_dword v12, v232, s[52:55], s15 offen sc1
    buffer_load_dword v13, v233, s[52:55], s15 offen sc1
    buffer_load_dword v14, v234, s[52:55], s15 offen sc1
    buffer_load_dword v15, v235, s[52:55], s15 offen sc1
    s_mov_b32 s15, 131072
    buffer_load_dword v16, v232, s[52:55], s15 offen sc1
    buffer_load_dword v17, v233, s[52:55], s15 offen sc1
    buffer_load_dword v18, v234, s[52:55], s15 offen sc1
    buffer_load_dword v19, v235, s[52:55], s15 offen sc1
    s_mov_b32 s15, 196608
    buffer_load_dword v20, v232, s[52:55], s15 offen sc1
    buffer_load_dword v21, v233, s[52:55], s15 offen sc1
    buffer_load_dword v22, v234, s[52:55], s15 offen sc1
    buffer_load_dword v23, v235, s[52:55], s15 offen sc1
    s_mov_b32 s15, 262144
    buffer_load_dword v24, v232, s[52:55], s15 offen sc1
    buffer_load_dword v25, v233, s[52:55], s15 offen sc1
    buffer_load_dword v26, v234, s[52:55], s15 offen sc1
    buffer_load_dword v27, v235, s[52:55], s15 offen sc1
    s_mov_b32 s15, 327680
    buffer_load_dword v28, v232, s[52:55], s15 offen sc1
    buffer_load_dword v29, v233, s[52:55], s15 offen sc1
    buffer_load_dword v30, v234, s[52:55], s15 offen sc1
    buffer_load_dword v31, v235, s[52:55], s15 offen sc1
    s_mov_b32 s15, 393216
    buffer_load_dword v32, v232, s[52:55], s15 offen sc1
    buffer_load_dword v33, v233, s[52:55], s15 offen sc1
    buffer_load_dword v34, v234, s[52:55], s15 offen sc1
    buffer_load_dword v35, v235, s[52:55], s15 offen sc1
    s_mov_b32 s15, 458752
    buffer_load_dword v36, v232, s[52:55], s15 offen sc1
    buffer_load_dword v37, v233, s[52:55], s15 offen sc1
    buffer_load_dword v38, v234, s[52:55], s15 offen sc1
    buffer_load_dword v39, v235, s[52:55], s15 offen sc1
    ds_read_b128 v[200:203], v7 offset:0
    ds_read_b128 v[204:207], v7 offset:29184
    ds_read_b128 v[208:211], v7 offset:58368
    ds_read_b128 v[212:215], v6 offset:0
    ds_read_b128 v[216:219], v7 offset:128
    ds_read_b128 v[220:223], v7 offset:29312
    ds_read_b128 v[224:227], v7 offset:58496
    ds_read_b128 v[228:231], v6 offset:128
    s_waitcnt vmcnt(28) lgkmcnt(7)
    v_mfma_f32_32x32x16_bf16 v[120:135], v[200:203], v[8:11], 0
    ds_read_b128 v[200:203], v7 offset:256
    s_mov_b32 s15, 524288
    buffer_load_dword v40, v232, s[52:55], s15 offen sc1
    s_waitcnt lgkmcnt(7)
    v_mfma_f32_32x32x16_bf16 v[136:151], v[204:207], v[8:11], 0
    ds_read_b128 v[204:207], v7 offset:29440
    buffer_load_dword v41, v233, s[52:55], s15 offen sc1
    s_waitcnt lgkmcnt(7)
    v_mfma_f32_32x32x16_bf16 v[152:167], v[208:211], v[8:11], 0
    ds_read_b128 v[208:211], v7 offset:58624
    buffer_load_dword v42, v234, s[52:55], s15 offen sc1
    s_waitcnt lgkmcnt(7)
    v_mfma_f32_32x32x16_bf16 v[168:183], v[212:215], v[8:11], 0
    ds_read_b128 v[212:215], v6 offset:256
    buffer_load_dword v43, v235, s[52:55], s15 offen sc1
    s_waitcnt vmcnt(28) lgkmcnt(7)
    v_mfma_f32_32x32x16_bf16 v[120:135], v[216:219], v[12:15], v[120:135]
    ds_read_b128 v[216:219], v7 offset:384
    s_mov_b32 s15, 589824
    buffer_load_dword v44, v232, s[52:55], s15 offen sc1
    s_waitcnt lgkmcnt(7)
    v_mfma_f32_32x32x16_bf16 v[136:151], v[220:223], v[12:15], v[136:151]
    ds_read_b128 v[220:223], v7 offset:29568
    buffer_load_dword v45, v233, s[52:55], s15 offen sc1
    s_waitcnt lgkmcnt(7)
    v_mfma_f32_32x32x16_bf16 v[152:167], v[224:227], v[12:15], v[152:167]
    ds_read_b128 v[224:227], v7 offset:58752
    buffer_load_dword v46, v234, s[52:55], s15 offen sc1
    s_waitcnt lgkmcnt(7)
    v_mfma_f32_32x32x16_bf16 v[168:183], v[228:231], v[12:15], v[168:183]
    ds_read_b128 v[228:231], v6 offset:384
    buffer_load_dword v47, v235, s[52:55], s15 offen sc1
    s_waitcnt vmcnt(28) lgkmcnt(7)
    v_mfma_f32_32x32x16_bf16 v[120:135], v[200:203], v[16:19], v[120:135]
    ds_read_b128 v[200:203], v7 offset:512
    s_mov_b32 s15, 655360
    buffer_load_dword v48, v232, s[52:55], s15 offen sc1
    s_waitcnt lgkmcnt(7)
    v_mfma_f32_32x32x16_bf16 v[136:151], v[204:207], v[16:19], v[136:151]
    ds_read_b128 v[204:207], v7 offset:29696
    buffer_load_dword v49, v233, s[52:55], s15 offen sc1
    s_waitcnt lgkmcnt(7)
    v_mfma_f32_32x32x16_bf16 v[152:167], v[208:211], v[16:19], v[152:167]
    ds_read_b128 v[208:211], v7 offset:58880
    buffer_load_dword v50, v234, s[52:55], s15 offen sc1
    s_waitcnt lgkmcnt(7)
    v_mfma_f32_32x32x16_bf16 v[168:183], v[212:215], v[16:19], v[168:183]
    ds_read_b128 v[212:215], v6 offset:512
    buffer_load_dword v51, v235, s[52:55], s15 offen sc1
    s_waitcnt vmcnt(28) lgkmcnt(7)
    v_mfma_f32_32x32x16_bf16 v[120:135], v[216:219], v[20:23], v[120:135]
    ds_read_b128 v[216:219], v7 offset:640
    s_mov_b32 s15, 720896
    buffer_load_dword v52, v232, s[52:55], s15 offen sc1
    s_waitcnt lgkmcnt(7)
    v_mfma_f32_32x32x16_bf16 v[136:151], v[220:223], v[20:23], v[136:151]
    ds_read_b128 v[220:223], v7 offset:29824
    buffer_load_dword v53, v233, s[52:55], s15 offen sc1
    s_waitcnt lgkmcnt(7)
    v_mfma_f32_32x32x16_bf16 v[152:167], v[224:227], v[20:23], v[152:167]
    ds_read_b128 v[224:227], v7 offset:59008
    buffer_load_dword v54, v234, s[52:55], s15 offen sc1
    s_waitcnt lgkmcnt(7)
    v_mfma_f32_32x32x16_bf16 v[168:183], v[228:231], v[20:23], v[168:183]
    ds_read_b128 v[228:231], v6 offset:640
    buffer_load_dword v55, v235, s[52:55], s15 offen sc1
    s_waitcnt vmcnt(28) lgkmcnt(7)
    v_mfma_f32_32x32x16_bf16 v[120:135], v[200:203], v[24:27], v[120:135]
    ds_read_b128 v[200:203], v7 offset:768
    s_mov_b32 s15, 786432
    buffer_load_dword v56, v232, s[52:55], s15 offen sc1
    s_waitcnt lgkmcnt(7)
    v_mfma_f32_32x32x16_bf16 v[136:151], v[204:207], v[24:27], v[136:151]
    ds_read_b128 v[204:207], v7 offset:29952
    buffer_load_dword v57, v233, s[52:55], s15 offen sc1
    s_waitcnt lgkmcnt(7)
    v_mfma_f32_32x32x16_bf16 v[152:167], v[208:211], v[24:27], v[152:167]
    ds_read_b128 v[208:211], v7 offset:59136
    buffer_load_dword v58, v234, s[52:55], s15 offen sc1
    s_waitcnt lgkmcnt(7)
    v_mfma_f32_32x32x16_bf16 v[168:183], v[212:215], v[24:27], v[168:183]
    ds_read_b128 v[212:215], v6 offset:768
    buffer_load_dword v59, v235, s[52:55], s15 offen sc1
    s_waitcnt vmcnt(28) lgkmcnt(7)
    v_mfma_f32_32x32x16_bf16 v[120:135], v[216:219], v[28:31], v[120:135]
    ds_read_b128 v[216:219], v7 offset:896
    s_mov_b32 s15, 851968
    buffer_load_dword v60, v232, s[52:55], s15 offen sc1
    s_waitcnt lgkmcnt(7)
    v_mfma_f32_32x32x16_bf16 v[136:151], v[220:223], v[28:31], v[136:151]
    ds_read_b128 v[220:223], v7 offset:30080
    buffer_load_dword v61, v233, s[52:55], s15 offen sc1
    s_waitcnt lgkmcnt(7)
    v_mfma_f32_32x32x16_bf16 v[152:167], v[224:227], v[28:31], v[152:167]
    ds_read_b128 v[224:227], v7 offset:59264
    buffer_load_dword v62, v234, s[52:55], s15 offen sc1
    s_waitcnt lgkmcnt(7)
    v_mfma_f32_32x32x16_bf16 v[168:183], v[228:231], v[28:31], v[168:183]
    ds_read_b128 v[228:231], v6 offset:896
    buffer_load_dword v63, v235, s[52:55], s15 offen sc1
    s_waitcnt vmcnt(28) lgkmcnt(7)
    v_mfma_f32_32x32x16_bf16 v[120:135], v[200:203], v[32:35], v[120:135]
    ds_read_b128 v[200:203], v7 offset:1024
    s_mov_b32 s15, 917504
    buffer_load_dword v64, v232, s[52:55], s15 offen sc1
    s_waitcnt lgkmcnt(7)
    v_mfma_f32_32x32x16_bf16 v[136:151], v[204:207], v[32:35], v[136:151]
    ds_read_b128 v[204:207], v7 offset:30208
    buffer_load_dword v65, v233, s[52:55], s15 offen sc1
    s_waitcnt lgkmcnt(7)
    v_mfma_f32_32x32x16_bf16 v[152:167], v[208:211], v[32:35], v[152:167]
    ds_read_b128 v[208:211], v7 offset:59392
    buffer_load_dword v66, v234, s[52:55], s15 offen sc1
    s_waitcnt lgkmcnt(7)
    v_mfma_f32_32x32x16_bf16 v[168:183], v[212:215], v[32:35], v[168:183]
    ds_read_b128 v[212:215], v6 offset:1024
    buffer_load_dword v67, v235, s[52:55], s15 offen sc1
    s_waitcnt vmcnt(28) lgkmcnt(7)
    v_mfma_f32_32x32x16_bf16 v[120:135], v[216:219], v[36:39], v[120:135]
    ds_read_b128 v[216:219], v7 offset:1152
    s_mov_b32 s15, 983040
    buffer_load_dword v68, v232, s[52:55], s15 offen sc1
    s_waitcnt lgkmcnt(7)
    v_mfma_f32_32x32x16_bf16 v[136:151], v[220:223], v[36:39], v[136:151]
    ds_read_b128 v[220:223], v7 offset:30336
    buffer_load_dword v69, v233, s[52:55], s15 offen sc1
    s_waitcnt lgkmcnt(7)
    v_mfma_f32_32x32x16_bf16 v[152:167], v[224:227], v[36:39], v[152:167]
    ds_read_b128 v[224:227], v7 offset:59520
    buffer_load_dword v70, v234, s[52:55], s15 offen sc1
    s_waitcnt lgkmcnt(7)
    v_mfma_f32_32x32x16_bf16 v[168:183], v[228:231], v[36:39], v[168:183]
    ds_read_b128 v[228:231], v6 offset:1152
    buffer_load_dword v71, v235, s[52:55], s15 offen sc1
    s_waitcnt vmcnt(28) lgkmcnt(7)
    v_mfma_f32_32x32x16_bf16 v[120:135], v[200:203], v[40:43], v[120:135]
    ds_read_b128 v[200:203], v7 offset:1280
    s_mov_b32 s15, 1048576
    buffer_load_dword v72, v232, s[52:55], s15 offen sc1
    s_waitcnt lgkmcnt(7)
    v_mfma_f32_32x32x16_bf16 v[136:151], v[204:207], v[40:43], v[136:151]
    ds_read_b128 v[204:207], v7 offset:30464
    buffer_load_dword v73, v233, s[52:55], s15 offen sc1
    s_waitcnt lgkmcnt(7)
    v_mfma_f32_32x32x16_bf16 v[152:167], v[208:211], v[40:43], v[152:167]
    ds_read_b128 v[208:211], v7 offset:59648
    buffer_load_dword v74, v234, s[52:55], s15 offen sc1
    s_waitcnt lgkmcnt(7)
    v_mfma_f32_32x32x16_bf16 v[168:183], v[212:215], v[40:43], v[168:183]
    ds_read_b128 v[212:215], v6 offset:1280
    buffer_load_dword v75, v235, s[52:55], s15 offen sc1
    s_waitcnt vmcnt(28) lgkmcnt(7)
    v_mfma_f32_32x32x16_bf16 v[120:135], v[216:219], v[44:47], v[120:135]
    ds_read_b128 v[216:219], v7 offset:1408
    s_mov_b32 s15, 1114112
    buffer_load_dword v76, v232, s[52:55], s15 offen sc1
    s_waitcnt lgkmcnt(7)
    v_mfma_f32_32x32x16_bf16 v[136:151], v[220:223], v[44:47], v[136:151]
    ds_read_b128 v[220:223], v7 offset:30592
    buffer_load_dword v77, v233, s[52:55], s15 offen sc1
    s_waitcnt lgkmcnt(7)
    v_mfma_f32_32x32x16_bf16 v[152:167], v[224:227], v[44:47], v[152:167]
    ds_read_b128 v[224:227], v7 offset:59776
    buffer_load_dword v78, v234, s[52:55], s15 offen sc1
    s_waitcnt lgkmcnt(7)
    v_mfma_f32_32x32x16_bf16 v[168:183], v[228:231], v[44:47], v[168:183]
    ds_read_b128 v[228:231], v6 offset:1408
    buffer_load_dword v79, v235, s[52:55], s15 offen sc1
    s_waitcnt vmcnt(28) lgkmcnt(7)
    v_mfma_f32_32x32x16_bf16 v[120:135], v[200:203], v[48:51], v[120:135]
    ds_read_b128 v[200:203], v7 offset:1536
    s_mov_b32 s15, 1179648
    buffer_load_dword v80, v232, s[52:55], s15 offen sc1
    s_waitcnt lgkmcnt(7)
    v_mfma_f32_32x32x16_bf16 v[136:151], v[204:207], v[48:51], v[136:151]
    ds_read_b128 v[204:207], v7 offset:30720
    buffer_load_dword v81, v233, s[52:55], s15 offen sc1
    s_waitcnt lgkmcnt(7)
    v_mfma_f32_32x32x16_bf16 v[152:167], v[208:211], v[48:51], v[152:167]
    ds_read_b128 v[208:211], v7 offset:59904
    buffer_load_dword v82, v234, s[52:55], s15 offen sc1
    s_waitcnt lgkmcnt(7)
    v_mfma_f32_32x32x16_bf16 v[168:183], v[212:215], v[48:51], v[168:183]
    ds_read_b128 v[212:215], v6 offset:1536
    buffer_load_dword v83, v235, s[52:55], s15 offen sc1
    s_waitcnt vmcnt(28) lgkmcnt(7)
    v_mfma_f32_32x32x16_bf16 v[120:135], v[216:219], v[52:55], v[120:135]
    ds_read_b128 v[216:219], v7 offset:1664
    s_mov_b32 s15, 1245184
    buffer_load_dword v84, v232, s[52:55], s15 offen sc1
    s_waitcnt lgkmcnt(7)
    v_mfma_f32_32x32x16_bf16 v[136:151], v[220:223], v[52:55], v[136:151]
    ds_read_b128 v[220:223], v7 offset:30848
    buffer_load_dword v85, v233, s[52:55], s15 offen sc1
    s_waitcnt lgkmcnt(7)
    v_mfma_f32_32x32x16_bf16 v[152:167], v[224:227], v[52:55], v[152:167]
    ds_read_b128 v[224:227], v7 offset:60032
    buffer_load_dword v86, v234, s[52:55], s15 offen sc1
    s_waitcnt lgkmcnt(7)
    v_mfma_f32_32x32x16_bf16 v[168:183], v[228:231], v[52:55], v[168:183]
    ds_read_b128 v[228:231], v6 offset:1664
    buffer_load_dword v87, v235, s[52:55], s15 offen sc1
    s_waitcnt vmcnt(28) lgkmcnt(7)
    v_mfma_f32_32x32x16_bf16 v[120:135], v[200:203], v[56:59], v[120:135]
    ds_read_b128 v[200:203], v7 offset:1792
    s_mov_b32 s15, 1310720
    buffer_load_dword v88, v232, s[52:55], s15 offen sc1
    s_waitcnt lgkmcnt(7)
    v_mfma_f32_32x32x16_bf16 v[136:151], v[204:207], v[56:59], v[136:151]
    ds_read_b128 v[204:207], v7 offset:30976
    buffer_load_dword v89, v233, s[52:55], s15 offen sc1
    s_waitcnt lgkmcnt(7)
    v_mfma_f32_32x32x16_bf16 v[152:167], v[208:211], v[56:59], v[152:167]
    ds_read_b128 v[208:211], v7 offset:60160
    buffer_load_dword v90, v234, s[52:55], s15 offen sc1
    s_waitcnt lgkmcnt(7)
    v_mfma_f32_32x32x16_bf16 v[168:183], v[212:215], v[56:59], v[168:183]
    ds_read_b128 v[212:215], v6 offset:1792
    buffer_load_dword v91, v235, s[52:55], s15 offen sc1
    s_waitcnt vmcnt(28) lgkmcnt(7)
    v_mfma_f32_32x32x16_bf16 v[120:135], v[216:219], v[60:63], v[120:135]
    ds_read_b128 v[216:219], v7 offset:1920
    s_mov_b32 s15, 1376256
    buffer_load_dword v92, v232, s[52:55], s15 offen sc1
    s_waitcnt lgkmcnt(7)
    v_mfma_f32_32x32x16_bf16 v[136:151], v[220:223], v[60:63], v[136:151]
    ds_read_b128 v[220:223], v7 offset:31104
    buffer_load_dword v93, v233, s[52:55], s15 offen sc1
    s_waitcnt lgkmcnt(7)
    v_mfma_f32_32x32x16_bf16 v[152:167], v[224:227], v[60:63], v[152:167]
    ds_read_b128 v[224:227], v7 offset:60288
    buffer_load_dword v94, v234, s[52:55], s15 offen sc1
    s_waitcnt lgkmcnt(7)
    v_mfma_f32_32x32x16_bf16 v[168:183], v[228:231], v[60:63], v[168:183]
    ds_read_b128 v[228:231], v6 offset:1920
    buffer_load_dword v95, v235, s[52:55], s15 offen sc1
    s_waitcnt vmcnt(28) lgkmcnt(7)
    v_mfma_f32_32x32x16_bf16 v[120:135], v[200:203], v[64:67], v[120:135]
    ds_read_b128 v[200:203], v7 offset:2048
    s_mov_b32 s15, 1441792
    buffer_load_dword v96, v232, s[52:55], s15 offen sc1
    s_waitcnt lgkmcnt(7)
    v_mfma_f32_32x32x16_bf16 v[136:151], v[204:207], v[64:67], v[136:151]
    ds_read_b128 v[204:207], v7 offset:31232
    buffer_load_dword v97, v233, s[52:55], s15 offen sc1
    s_waitcnt lgkmcnt(7)
    v_mfma_f32_32x32x16_bf16 v[152:167], v[208:211], v[64:67], v[152:167]
    ds_read_b128 v[208:211], v7 offset:60416
    buffer_load_dword v98, v234, s[52:55], s15 offen sc1
    s_waitcnt lgkmcnt(7)
    v_mfma_f32_32x32x16_bf16 v[168:183], v[212:215], v[64:67], v[168:183]
    ds_read_b128 v[212:215], v6 offset:2048
    buffer_load_dword v99, v235, s[52:55], s15 offen sc1
    s_waitcnt vmcnt(28) lgkmcnt(7)
    v_mfma_f32_32x32x16_bf16 v[120:135], v[216:219], v[68:71], v[120:135]
    ds_read_b128 v[216:219], v7 offset:2176
    s_mov_b32 s15, 1507328
    buffer_load_dword v100, v232, s[52:55], s15 offen sc1
    s_waitcnt lgkmcnt(7)
    v_mfma_f32_32x32x16_bf16 v[136:151], v[220:223], v[68:71], v[136:151]
    ds_read_b128 v[220:223], v7 offset:31360
    buffer_load_dword v101, v233, s[52:55], s15 offen sc1
    s_waitcnt lgkmcnt(7)
    v_mfma_f32_32x32x16_bf16 v[152:167], v[224:227], v[68:71], v[152:167]
    ds_read_b128 v[224:227], v7 offset:60544
    buffer_load_dword v102, v234, s[52:55], s15 offen sc1
    s_waitcnt lgkmcnt(7)
    v_mfma_f32_32x32x16_bf16 v[168:183], v[228:231], v[68:71], v[168:183]
    ds_read_b128 v[228:231], v6 offset:2176
    buffer_load_dword v103, v235, s[52:55], s15 offen sc1
    s_waitcnt vmcnt(28) lgkmcnt(7)
    v_mfma_f32_32x32x16_bf16 v[120:135], v[200:203], v[72:75], v[120:135]
    ds_read_b128 v[200:203], v7 offset:2304
    s_mov_b32 s15, 1572864
    buffer_load_dword v104, v232, s[52:55], s15 offen sc1
    s_waitcnt lgkmcnt(7)
    v_mfma_f32_32x32x16_bf16 v[136:151], v[204:207], v[72:75], v[136:151]
    ds_read_b128 v[204:207], v7 offset:31488
    buffer_load_dword v105, v233, s[52:55], s15 offen sc1
    s_waitcnt lgkmcnt(7)
    v_mfma_f32_32x32x16_bf16 v[152:167], v[208:211], v[72:75], v[152:167]
    ds_read_b128 v[208:211], v7 offset:60672
    buffer_load_dword v106, v234, s[52:55], s15 offen sc1
    s_waitcnt lgkmcnt(7)
    v_mfma_f32_32x32x16_bf16 v[168:183], v[212:215], v[72:75], v[168:183]
    ds_read_b128 v[212:215], v6 offset:2304
    buffer_load_dword v107, v235, s[52:55], s15 offen sc1
    s_waitcnt vmcnt(28) lgkmcnt(7)
    v_mfma_f32_32x32x16_bf16 v[120:135], v[216:219], v[76:79], v[120:135]
    ds_read_b128 v[216:219], v7 offset:2432
    s_mov_b32 s15, 1638400
    buffer_load_dword v108, v232, s[52:55], s15 offen sc1
    s_waitcnt lgkmcnt(7)
    v_mfma_f32_32x32x16_bf16 v[136:151], v[220:223], v[76:79], v[136:151]
    ds_read_b128 v[220:223], v7 offset:31616
    buffer_load_dword v109, v233, s[52:55], s15 offen sc1
    s_waitcnt lgkmcnt(7)
    v_mfma_f32_32x32x16_bf16 v[152:167], v[224:227], v[76:79], v[152:167]
    ds_read_b128 v[224:227], v7 offset:60800
    buffer_load_dword v110, v234, s[52:55], s15 offen sc1
    s_waitcnt lgkmcnt(7)
    v_mfma_f32_32x32x16_bf16 v[168:183], v[228:231], v[76:79], v[168:183]
    ds_read_b128 v[228:231], v6 offset:2432
    buffer_load_dword v111, v235, s[52:55], s15 offen sc1
    s_waitcnt vmcnt(28) lgkmcnt(7)
    v_mfma_f32_32x32x16_bf16 v[120:135], v[200:203], v[80:83], v[120:135]
    ds_read_b128 v[200:203], v7 offset:2560
    s_mov_b32 s15, 1703936
    buffer_load_dword v112, v232, s[52:55], s15 offen sc1
    s_waitcnt lgkmcnt(7)
    v_mfma_f32_32x32x16_bf16 v[136:151], v[204:207], v[80:83], v[136:151]
    ds_read_b128 v[204:207], v7 offset:31744
    buffer_load_dword v113, v233, s[52:55], s15 offen sc1
    s_waitcnt lgkmcnt(7)
    v_mfma_f32_32x32x16_bf16 v[152:167], v[208:211], v[80:83], v[152:167]
    ds_read_b128 v[208:211], v7 offset:60928
    buffer_load_dword v114, v234, s[52:55], s15 offen sc1
    s_waitcnt lgkmcnt(7)
    v_mfma_f32_32x32x16_bf16 v[168:183], v[212:215], v[80:83], v[168:183]
    ds_read_b128 v[212:215], v6 offset:2560
    buffer_load_dword v115, v235, s[52:55], s15 offen sc1
    s_waitcnt vmcnt(28) lgkmcnt(7)
    v_mfma_f32_32x32x16_bf16 v[120:135], v[216:219], v[84:87], v[120:135]
    ds_read_b128 v[216:219], v7 offset:2688
    s_mov_b32 s15, 1769472
    buffer_load_dword v116, v232, s[52:55], s15 offen sc1
    s_waitcnt lgkmcnt(7)
    v_mfma_f32_32x32x16_bf16 v[136:151], v[220:223], v[84:87], v[136:151]
    ds_read_b128 v[220:223], v7 offset:31872
    buffer_load_dword v117, v233, s[52:55], s15 offen sc1
    s_waitcnt lgkmcnt(7)
    v_mfma_f32_32x32x16_bf16 v[152:167], v[224:227], v[84:87], v[152:167]
    ds_read_b128 v[224:227], v7 offset:61056
    buffer_load_dword v118, v234, s[52:55], s15 offen sc1
    s_waitcnt lgkmcnt(7)
    v_mfma_f32_32x32x16_bf16 v[168:183], v[228:231], v[84:87], v[168:183]
    ds_read_b128 v[228:231], v6 offset:2688
    buffer_load_dword v119, v235, s[52:55], s15 offen sc1
    s_waitcnt vmcnt(28) lgkmcnt(7)
    v_mfma_f32_32x32x16_bf16 v[120:135], v[200:203], v[88:91], v[120:135]
    ds_read_b128 v[200:203], v7 offset:2816
    s_waitcnt lgkmcnt(7)
    v_mfma_f32_32x32x16_bf16 v[136:151], v[204:207], v[88:91], v[136:151]
    ds_read_b128 v[204:207], v7 offset:32000
    s_waitcnt lgkmcnt(7)
    v_mfma_f32_32x32x16_bf16 v[152:167], v[208:211], v[88:91], v[152:167]
    ds_read_b128 v[208:211], v7 offset:61184
    s_waitcnt lgkmcnt(7)
    v_mfma_f32_32x32x16_bf16 v[168:183], v[212:215], v[88:91], v[168:183]
    ds_read_b128 v[212:215], v6 offset:2816
    s_waitcnt vmcnt(24) lgkmcnt(7)
    v_mfma_f32_32x32x16_bf16 v[120:135], v[216:219], v[92:95], v[120:135]
    ds_read_b128 v[216:219], v7 offset:2944
    s_waitcnt lgkmcnt(7)
    v_mfma_f32_32x32x16_bf16 v[136:151], v[220:223], v[92:95], v[136:151]
    ds_read_b128 v[220:223], v7 offset:32128
    s_waitcnt lgkmcnt(7)
    v_mfma_f32_32x32x16_bf16 v[152:167], v[224:227], v[92:95], v[152:167]
    ds_read_b128 v[224:227], v7 offset:61312
    s_waitcnt lgkmcnt(7)
    v_mfma_f32_32x32x16_bf16 v[168:183], v[228:231], v[92:95], v[168:183]
    ds_read_b128 v[228:231], v6 offset:2944
    s_waitcnt vmcnt(20) lgkmcnt(7)
    v_mfma_f32_32x32x16_bf16 v[120:135], v[200:203], v[96:99], v[120:135]
    ds_read_b128 v[200:203], v7 offset:3072
    s_waitcnt lgkmcnt(7)
    v_mfma_f32_32x32x16_bf16 v[136:151], v[204:207], v[96:99], v[136:151]
    ds_read_b128 v[204:207], v7 offset:32256
    s_waitcnt lgkmcnt(7)
    v_mfma_f32_32x32x16_bf16 v[152:167], v[208:211], v[96:99], v[152:167]
    ds_read_b128 v[208:211], v7 offset:61440
    s_waitcnt lgkmcnt(7)
    v_mfma_f32_32x32x16_bf16 v[168:183], v[212:215], v[96:99], v[168:183]
    ds_read_b128 v[212:215], v6 offset:3072
    s_waitcnt vmcnt(16) lgkmcnt(7)
    v_mfma_f32_32x32x16_bf16 v[120:135], v[216:219], v[100:103], v[120:135]
    ds_read_b128 v[216:219], v7 offset:3200
    s_waitcnt lgkmcnt(7)
    v_mfma_f32_32x32x16_bf16 v[136:151], v[220:223], v[100:103], v[136:151]
    ds_read_b128 v[220:223], v7 offset:32384
    s_waitcnt lgkmcnt(7)
    v_mfma_f32_32x32x16_bf16 v[152:167], v[224:227], v[100:103], v[152:167]
    ds_read_b128 v[224:227], v7 offset:61568
    s_waitcnt lgkmcnt(7)
    v_mfma_f32_32x32x16_bf16 v[168:183], v[228:231], v[100:103], v[168:183]
    ds_read_b128 v[228:231], v6 offset:3200
    s_waitcnt vmcnt(12) lgkmcnt(7)
    v_mfma_f32_32x32x16_bf16 v[120:135], v[200:203], v[104:107], v[120:135]
    ds_read_b128 v[200:203], v7 offset:3328
    s_waitcnt lgkmcnt(7)
    v_mfma_f32_32x32x16_bf16 v[136:151], v[204:207], v[104:107], v[136:151]
    ds_read_b128 v[204:207], v7 offset:32512
    s_waitcnt lgkmcnt(7)
    v_mfma_f32_32x32x16_bf16 v[152:167], v[208:211], v[104:107], v[152:167]
    ds_read_b128 v[208:211], v7 offset:61696
    s_waitcnt lgkmcnt(7)
    v_mfma_f32_32x32x16_bf16 v[168:183], v[212:215], v[104:107], v[168:183]
    ds_read_b128 v[212:215], v6 offset:3328
    s_waitcnt vmcnt(8) lgkmcnt(7)
    v_mfma_f32_32x32x16_bf16 v[120:135], v[216:219], v[108:111], v[120:135]
    ds_read_b128 v[216:219], v7 offset:3456
    s_waitcnt lgkmcnt(7)
    v_mfma_f32_32x32x16_bf16 v[136:151], v[220:223], v[108:111], v[136:151]
    ds_read_b128 v[220:223], v7 offset:32640
    s_waitcnt lgkmcnt(7)
    v_mfma_f32_32x32x16_bf16 v[152:167], v[224:227], v[108:111], v[152:167]
    ds_read_b128 v[224:227], v7 offset:61824
    s_waitcnt lgkmcnt(7)
    v_mfma_f32_32x32x16_bf16 v[168:183], v[228:231], v[108:111], v[168:183]
    ds_read_b128 v[228:231], v6 offset:3456
    global_load_dwordx4 v[236:239], v247, s[50:51] sc1
    s_waitcnt vmcnt(5) lgkmcnt(7)
    v_mfma_f32_32x32x16_bf16 v[120:135], v[200:203], v[112:115], v[120:135]
    ds_read_b128 v[200:203], v6 offset:29184
    s_waitcnt lgkmcnt(7)
    v_mfma_f32_32x32x16_bf16 v[136:151], v[204:207], v[112:115], v[136:151]
    ds_read_b128 v[204:207], v6 offset:29312
    s_waitcnt lgkmcnt(7)
    v_mfma_f32_32x32x16_bf16 v[152:167], v[208:211], v[112:115], v[152:167]
    ds_read_b128 v[208:211], v6 offset:29440
    s_waitcnt lgkmcnt(7)
    v_mfma_f32_32x32x16_bf16 v[168:183], v[212:215], v[112:115], v[168:183]
    ds_read_b128 v[212:215], v6 offset:29568
    s_waitcnt vmcnt(1) lgkmcnt(7)
    v_mfma_f32_32x32x16_bf16 v[120:135], v[216:219], v[116:119], v[120:135]
    s_waitcnt lgkmcnt(6)
    v_mfma_f32_32x32x16_bf16 v[136:151], v[220:223], v[116:119], v[136:151]
    s_waitcnt lgkmcnt(5)
    v_mfma_f32_32x32x16_bf16 v[152:167], v[224:227], v[116:119], v[152:167]
    s_waitcnt lgkmcnt(4)
    v_mfma_f32_32x32x16_bf16 v[168:183], v[228:231], v[116:119], v[168:183]
    s_barrier
    v_mov_b32 v2, s62
    ds_read_b128 v[216:219], v246 offset:0
    ds_read_b128 v[220:223], v246 offset:64
    ds_read_b128 v[224:227], v246 offset:128
    ds_read_b128 v[228:231], v246 offset:192
    s_mov_b32 s64, 0
    s_branch pskip_16
poll_14:
    global_load_dwordx4 v[236:239], v247, s[50:51] sc1
pskip_16:
    s_waitcnt vmcnt(0)
    v_xor_b32 v237, s7, v237
    v_xor_b32 v239, s7, v239
    v_or_b32 v237, v237, v239
    v_cmp_ne_u32 vcc, 0, v237
    s_cbranch_vccz pdone_15
    s_add_u32 s64, s64, 1
    s_cmp_lt_u32 s64, 20000
    s_sleep 1
    s_cbranch_scc1 poll_14
pdone_15:
    s_waitcnt lgkmcnt(7)
    v_mfma_f32_32x32x16_bf16 v[184:199], v[200:203], v[8:11], 0
    ds_read_b128 v[200:203], v6 offset:29696
    s_waitcnt lgkmcnt(1)
    v_fmac_f32 v220, v236, v216
    v_fmac_f32 v228, v236, v224
    v_fmac_f32 v221, v236, v217
    v_fmac_f32 v229, v236, v225
    v_fmac_f32 v222, v236, v218
    s_waitcnt lgkmcnt(7)
    v_mfma_f32_32x32x16_bf16 v[184:199], v[204:207], v[12:15], v[184:199]
    ds_read_b128 v[204:207], v6 offset:29824
    v_fmac_f32 v230, v236, v226
    v_fmac_f32 v223, v236, v219
    v_fmac_f32 v231, v236, v227
    v_fmac_f32 v220, v238, v120
    v_fmac_f32 v228, v238, v128
    v_fmac_f32 v221, v238, v121
    s_waitcnt lgkmcnt(7)
    v_mfma_f32_32x32x16_bf16 v[184:199], v[208:211], v[16:19], v[184:199]
    ds_read_b128 v[208:211], v6 offset:29952
    v_fmac_f32 v229, v238, v129
    v_fmac_f32 v222, v238, v122
    v_fmac_f32 v230, v238, v130
    v_fmac_f32 v223, v238, v123
    v_fmac_f32 v231, v238, v131
    s_waitcnt lgkmcnt(7)
    v_mfma_f32_32x32x16_bf16 v[184:199], v[212:215], v[20:23], v[184:199]
    ds_read_b128 v[212:215], v6 offset:30080
    v_mul_f32 v220, v220, v228
    v_mul_f32 v221, v221, v229
    v_mul_f32 v222, v222, v230
    v_mul_f32 v223, v223, v231
    v_cvt_pk_bf16_f32 v240, v220, v221
    v_cvt_pk_bf16_f32 v241, v222, v223
    s_waitcnt lgkmcnt(3)
    v_mfma_f32_32x32x16_bf16 v[184:199], v[200:203], v[24:27], v[184:199]
    ds_read_b128 v[200:203], v6 offset:30208
    ds_read_b128 v[216:219], v246 offset:32
    ds_read_b128 v[220:223], v246 offset:96
    ds_read_b128 v[224:227], v246 offset:160
    ds_read_b128 v[228:231], v246 offset:224
    s_waitcnt lgkmcnt(7)
    v_mfma_f32_32x32x16_bf16 v[184:199], v[204:207], v[28:31], v[184:199]
    ds_read_b128 v[204:207], v6 offset:30336
    s_waitcnt lgkmcnt(7)
    v_mfma_f32_32x32x16_bf16 v[184:199], v[208:211], v[32:35], v[184:199]
    ds_read_b128 v[208:211], v6 offset:30464
    s_waitcnt lgkmcnt(2)
    v_fmac_f32 v220, v236, v216
    v_fmac_f32 v228, v236, v224
    v_fmac_f32 v221, v236, v217
    v_fmac_f32 v229, v236, v225
    v_fmac_f32 v222, v236, v218
    v_fmac_f32 v230, v236, v226
    v_fmac_f32 v223, v236, v219
    v_fmac_f32 v231, v236, v227
    v_fmac_f32 v220, v238, v124
    v_fmac_f32 v228, v238, v132
    v_fmac_f32 v221, v238, v125
    v_fmac_f32 v229, v238, v133
    s_waitcnt lgkmcnt(7)
    v_mfma_f32_32x32x16_bf16 v[184:199], v[212:215], v[36:39], v[184:199]
    ds_read_b128 v[212:215], v6 offset:30592
    v_fmac_f32 v222, v238, v126
    v_fmac_f32 v230, v238, v134
    v_fmac_f32 v223, v238, v127
    v_fmac_f32 v231, v238, v135
    ds_read_b128 v[120:123], v246 offset:256
    ds_read_b128 v[124:127], v246 offset:320
    ds_read_b128 v[128:131], v246 offset:384
    ds_read_b128 v[132:135], v246 offset:448
    v_mul_f32 v220, v220, v228
    s_waitcnt lgkmcnt(11)
    v_mfma_f32_32x32x16_bf16 v[184:199], v[200:203], v[40:43], v[184:199]
    ds_read_b128 v[200:203], v6 offset:30720
    v_mul_f32 v221, v221, v229
    v_mul_f32 v222, v222, v230
    v_mul_f32 v223, v223, v231
    v_cvt_pk_bf16_f32 v242, v220, v221
    v_cvt_pk_bf16_f32 v243, v222, v223
    s_waitcnt lgkmcnt(7)
    v_mfma_f32_32x32x16_bf16 v[184:199], v[204:207], v[44:47], v[184:199]
    ds_read_b128 v[204:207], v6 offset:30848
    global_store_dwordx4 v244, v[240:243], s[50:51] offset:0 sc1
    s_waitcnt lgkmcnt(2)
    v_fmac_f32 v124, v236, v120
    ds_read_b128 v[216:219], v246 offset:288
    ds_read_b128 v[220:223], v246 offset:352
    ds_read_b128 v[224:227], v246 offset:416
    ds_read_b128 v[228:231], v246 offset:480
    v_fmac_f32 v132, v236, v128
    v_fmac_f32 v125, v236, v121
    s_waitcnt lgkmcnt(11)
    v_mfma_f32_32x32x16_bf16 v[184:199], v[208:211], v[48:51], v[184:199]
    ds_read_b128 v[208:211], v6 offset:30976
    v_fmac_f32 v133, v236, v129
    v_fmac_f32 v126, v236, v122
    v_fmac_f32 v134, v236, v130
    v_fmac_f32 v127, v236, v123
    v_fmac_f32 v135, v236, v131
    s_waitcnt lgkmcnt(11)
    v_mfma_f32_32x32x16_bf16 v[184:199], v[212:215], v[52:55], v[184:199]
    ds_read_b128 v[212:215], v6 offset:31104
    v_fmac_f32 v124, v238, v136
    v_fmac_f32 v132, v238, v144
    v_fmac_f32 v125, v238, v137
    v_fmac_f32 v133, v238, v145
    v_fmac_f32 v126, v238, v138
    v_fmac_f32 v134, v238, v146
    s_waitcnt lgkmcnt(7)
    v_mfma_f32_32x32x16_bf16 v[184:199], v[200:203], v[56:59], v[184:199]
    ds_read_b128 v[200:203], v6 offset:31232
    v_fmac_f32 v127, v238, v139
    v_fmac_f32 v135, v238, v147
    v_mul_f32 v124, v124, v132
    v_mul_f32 v125, v125, v133
    v_mul_f32 v126, v126, v134
    s_waitcnt lgkmcnt(7)
    v_mfma_f32_32x32x16_bf16 v[184:199], v[204:207], v[60:63], v[184:199]
    ds_read_b128 v[204:207], v6 offset:31360
    v_mul_f32 v127, v127, v135
    v_cvt_pk_bf16_f32 v240, v124, v125
    v_cvt_pk_bf16_f32 v241, v126, v127
    s_waitcnt lgkmcnt(4)
    v_fmac_f32 v220, v236, v216
    ds_read_b128 v[120:123], v246 offset:512
    ds_read_b128 v[124:127], v246 offset:576
    ds_read_b128 v[128:131], v246 offset:640
    ds_read_b128 v[132:135], v246 offset:704
    s_waitcnt lgkmcnt(7)
    v_mfma_f32_32x32x16_bf16 v[184:199], v[208:211], v[64:67], v[184:199]
    ds_read_b128 v[208:211], v6 offset:31488
    v_fmac_f32 v228, v236, v224
    v_fmac_f32 v221, v236, v217
    v_fmac_f32 v229, v236, v225
    v_fmac_f32 v222, v236, v218
    v_fmac_f32 v230, v236, v226
    s_waitcnt lgkmcnt(7)
    v_mfma_f32_32x32x16_bf16 v[184:199], v[212:215], v[68:71], v[184:199]
    ds_read_b128 v[212:215], v6 offset:31616
    v_fmac_f32 v223, v236, v219
    v_fmac_f32 v231, v236, v227
    v_fmac_f32 v220, v238, v140
    v_fmac_f32 v228, v238, v148
    v_fmac_f32 v221, v238, v141
    v_fmac_f32 v229, v238, v149
    s_waitcnt lgkmcnt(7)
    v_mfma_f32_32x32x16_bf16 v[184:199], v[200:203], v[72:75], v[184:199]
    ds_read_b128 v[200:203], v6 offset:31744
    v_fmac_f32 v222, v238, v142
    v_fmac_f32 v230, v238, v150
    v_fmac_f32 v223, v238, v143
    v_fmac_f32 v231, v238, v151
    v_mul_f32 v220, v220, v228
    s_waitcnt lgkmcnt(7)
    v_mfma_f32_32x32x16_bf16 v[184:199], v[204:207], v[76:79], v[184:199]
    ds_read_b128 v[204:207], v6 offset:31872
    v_mul_f32 v221, v221, v229
    v_mul_f32 v222, v222, v230
    v_mul_f32 v223, v223, v231
    v_cvt_pk_bf16_f32 v242, v220, v221
    v_cvt_pk_bf16_f32 v243, v222, v223
    global_store_dwordx4 v244, v[240:243], s[50:51] offset:1024 sc1
    s_waitcnt lgkmcnt(3)
    v_mfma_f32_32x32x16_bf16 v[184:199], v[208:211], v[80:83], v[184:199]
    ds_read_b128 v[208:211], v6 offset:32000
    s_waitcnt lgkmcnt(5)
    v_fmac_f32 v124, v236, v120
    ds_read_b128 v[216:219], v246 offset:544
    ds_read_b128 v[220:223], v246 offset:608
    ds_read_b128 v[224:227], v246 offset:672
    ds_read_b128 v[228:231], v246 offset:736
    v_fmac_f32 v132, v236, v128
    v_fmac_f32 v125, v236, v121
    s_waitcnt lgkmcnt(7)
    v_mfma_f32_32x32x16_bf16 v[184:199], v[212:215], v[84:87], v[184:199]
    ds_read_b128 v[212:215], v6 offset:32128
    v_fmac_f32 v133, v236, v129
    v_fmac_f32 v126, v236, v122
    v_fmac_f32 v134, v236, v130
    v_fmac_f32 v127, v236, v123
    v_fmac_f32 v135, v236, v131
    v_fmac_f32 v124, v238, v152
    s_waitcnt lgkmcnt(7)
    v_mfma_f32_32x32x16_bf16 v[184:199], v[200:203], v[88:91], v[184:199]
    ds_read_b128 v[200:203], v6 offset:32256
    v_fmac_f32 v132, v238, v160
    v_fmac_f32 v125, v238, v153
    v_fmac_f32 v133, v238, v161
    v_fmac_f32 v126, v238, v154
    v_fmac_f32 v134, v238, v162
    s_waitcnt lgkmcnt(7)
    v_mfma_f32_32x32x16_bf16 v[184:199], v[204:207], v[92:95], v[184:199]
    ds_read_b128 v[204:207], v6 offset:32384
    v_fmac_f32 v127, v238, v155
    v_fmac_f32 v135, v238, v163
    v_mul_f32 v124, v124, v132
    v_mul_f32 v125, v125, v133
    v_mul_f32 v126, v126, v134
    v_mul_f32 v127, v127, v135
    s_waitcnt lgkmcnt(7)
    v_mfma_f32_32x32x16_bf16 v[184:199], v[208:211], v[96:99], v[184:199]
    ds_read_b128 v[208:211], v6 offset:32512
    v_cvt_pk_bf16_f32 v240, v124, v125
    v_cvt_pk_bf16_f32 v241, v126, v127
    s_waitcnt lgkmcnt(4)
    v_fmac_f32 v220, v236, v216
    ds_read_b128 v[136:139], v246 offset:768
    ds_read_b128 v[140:143], v246 offset:832
    ds_read_b128 v[144:147], v246 offset:896
    ds_read_b128 v[148:151], v246 offset:960
    s_waitcnt lgkmcnt(7)
    v_mfma_f32_32x32x16_bf16 v[184:199], v[212:215], v[100:103], v[184:199]
    ds_read_b128 v[212:215], v6 offset:32640
    v_fmac_f32 v228, v236, v224
    v_fmac_f32 v221, v236, v217
    v_fmac_f32 v229, v236, v225
    v_fmac_f32 v222, v236, v218
    v_fmac_f32 v230, v236, v226
    v_fmac_f32 v223, v236, v219
    s_waitcnt lgkmcnt(7)
    v_mfma_f32_32x32x16_bf16 v[184:199], v[200:203], v[104:107], v[184:199]
    s_barrier
    ds_read_b128 v[200:203], v7 offset:0
    v_fmac_f32 v231, v236, v227
    v_fmac_f32 v220, v238, v156
    v_fmac_f32 v228, v238, v164
    v_fmac_f32 v221, v238, v157
    v_fmac_f32 v229, v238, v165
    s_waitcnt lgkmcnt(7)
    v_mfma_f32_32x32x16_bf16 v[184:199], v[204:207], v[108:111], v[184:199]
    ds_read_b128 v[204:207], v7 offset:128
    v_fmac_f32 v222, v238, v158
    v_fmac_f32 v230, v238, v166
    v_fmac_f32 v223, v238, v159
    v_fmac_f32 v231, v238, v167
    v_mul_f32 v220, v220, v228
    v_mul_f32 v221, v221, v229
    s_waitcnt lgkmcnt(7)
    v_mfma_f32_32x32x16_bf16 v[184:199], v[208:211], v[112:115], v[184:199]
    ds_read_b128 v[208:211], v7 offset:256
    v_mul_f32 v222, v222, v230
    v_mul_f32 v223, v223, v231
    v_cvt_pk_bf16_f32 v242, v220, v221
    v_cvt_pk_bf16_f32 v243, v222, v223
    global_store_dwordx4 v244, v[240:243], s[50:51] offset:2048 sc1
    s_waitcnt lgkmcnt(3)
    v_mfma_f32_32x32x16_bf16 v[184:199], v[212:215], v[116:119], v[184:199]
    ds_read_b128 v[212:215], v7 offset:384
    v_mov_b32 v4, s61
    v_mov_b32 v5, 1
    ds_write_b32 v4, v5 offset:0
    s_waitcnt lgkmcnt(4)
    v_mfma_f32_32x32x16_bf16 v[120:135], v[200:203], v[8:11], 0
    ds_read_b128 v[200:203], v7 offset:512
    s_waitcnt lgkmcnt(7)
    v_fmac_f32 v140, v236, v136
    ds_read_b128 v[216:219], v246 offset:800
    ds_read_b128 v[220:223], v246 offset:864
    ds_read_b128 v[224:227], v246 offset:928
    ds_read_b128 v[228:231], v246 offset:992
    v_fmac_f32 v148, v236, v144
    s_waitcnt lgkmcnt(8)
    v_mfma_f32_32x32x16_bf16 v[120:135], v[204:207], v[12:15], v[120:135]
    ds_read_b128 v[204:207], v7 offset:640
    v_fmac_f32 v141, v236, v137
    v_fmac_f32 v149, v236, v145
    v_fmac_f32 v142, v236, v138
    v_fmac_f32 v150, v236, v146
    s_waitcnt lgkmcnt(8)
    v_mfma_f32_32x32x16_bf16 v[120:135], v[208:211], v[16:19], v[120:135]
    ds_read_b128 v[208:211], v7 offset:768
    v_fmac_f32 v143, v236, v139
    v_fmac_f32 v151, v236, v147
    v_fmac_f32 v140, v238, v168
    s_waitcnt lgkmcnt(8)
    v_mfma_f32_32x32x16_bf16 v[120:135], v[212:215], v[20:23], v[120:135]
    ds_read_b128 v[212:215], v7 offset:896
    v_fmac_f32 v148, v238, v176
    v_fmac_f32 v141, v238, v169
    v_fmac_f32 v149, v238, v177
    v_fmac_f32 v142, v238, v170
    s_waitcnt lgkmcnt(7)
    v_mfma_f32_32x32x16_bf16 v[120:135], v[200:203], v[24:27], v[120:135]
    ds_read_b128 v[200:203], v7 offset:1024
    v_fmac_f32 v150, v238, v178
    v_fmac_f32 v143, v238, v171
    v_fmac_f32 v151, v238, v179
    v_mul_f32 v140, v140, v148
    s_waitcnt lgkmcnt(3)
    v_mfma_f32_32x32x16_bf16 v[120:135], v[204:207], v[28:31], v[120:135]
    ds_read_b128 v[204:207], v7 offset:1152
    v_mul_f32 v141, v141, v149
    v_mul_f32 v142, v142, v150
    v_mul_f32 v143, v143, v151
    s_waitcnt lgkmcnt(3)
    v_mfma_f32_32x32x16_bf16 v[120:135], v[208:211], v[32:35], v[120:135]
    ds_read_b128 v[208:211], v7 offset:1280
    v_cvt_pk_bf16_f32 v240, v140, v141
    v_cvt_pk_bf16_f32 v241, v142, v143
    s_waitcnt lgkmcnt(6)
    v_fmac_f32 v220, v236, v216
    s_waitcnt lgkmcnt(3)
    v_mfma_f32_32x32x16_bf16 v[120:135], v[212:215], v[36:39], v[120:135]
    ds_read_b128 v[212:215], v7 offset:1408
    ds_read_b128 v[152:155], v246 offset:1024
    ds_read_b128 v[156:159], v246 offset:1088
    ds_read_b128 v[160:163], v246 offset:1152
    ds_read_b128 v[164:167], v246 offset:1216
    v_fmac_f32 v228, v236, v224
    v_fmac_f32 v221, v236, v217
    v_fmac_f32 v229, v236, v225
    s_waitcnt lgkmcnt(7)
    v_mfma_f32_32x32x16_bf16 v[120:135], v[200:203], v[40:43], v[120:135]
    ds_read_b128 v[200:203], v7 offset:1536
    v_fmac_f32 v222, v236, v218
    v_fmac_f32 v230, v236, v226
    v_fmac_f32 v223, v236, v219
    s_waitcnt lgkmcnt(7)
    v_mfma_f32_32x32x16_bf16 v[120:135], v[204:207], v[44:47], v[120:135]
    ds_read_b128 v[204:207], v7 offset:1664
    v_fmac_f32 v231, v236, v227
    v_fmac_f32 v220, v238, v172
    v_fmac_f32 v228, v238, v180
    v_fmac_f32 v221, v238, v173
    s_waitcnt lgkmcnt(7)
    v_mfma_f32_32x32x16_bf16 v[120:135], v[208:211], v[48:51], v[120:135]
    ds_read_b128 v[208:211], v7 offset:1792
    v_fmac_f32 v229, v238, v181
    v_fmac_f32 v222, v238, v174
    v_fmac_f32 v230, v238, v182
    s_waitcnt lgkmcnt(7)
    v_mfma_f32_32x32x16_bf16 v[120:135], v[212:215], v[52:55], v[120:135]
    ds_read_b128 v[212:215], v7 offset:1920
    v_fmac_f32 v223, v238, v175
    v_fmac_f32 v231, v238, v183
    v_mul_f32 v220, v220, v228
    v_mul_f32 v221, v221, v229
    s_waitcnt lgkmcnt(3)
    v_mfma_f32_32x32x16_bf16 v[120:135], v[200:203], v[56:59], v[120:135]
    ds_read_b128 v[200:203], v7 offset:2048
    v_mul_f32 v222, v222, v230
    v_mul_f32 v223, v223, v231
    v_cvt_pk_bf16_f32 v242, v220, v221
    v_cvt_pk_bf16_f32 v243, v222, v223
    s_waitcnt lgkmcnt(3)
    v_mfma_f32_32x32x16_bf16 v[120:135], v[204:207], v[60:63], v[120:135]
    ds_read_b128 v[204:207], v7 offset:2176
    global_store_dwordx4 v244, v[240:243], s[50:51] offset:3072 sc1
    s_waitcnt lgkmcnt(6)
    v_fmac_f32 v156, v236, v152
    s_waitcnt lgkmcnt(3)
    v_mfma_f32_32x32x16_bf16 v[120:135], v[208:211], v[64:67], v[120:135]
    ds_read_b128 v[208:211], v7 offset:2304
    ds_read_b128 v[216:219], v246 offset:1056
    ds_read_b128 v[220:223], v246 offset:1120
    ds_read_b128 v[224:227], v246 offset:1184
    ds_read_b128 v[228:231], v246 offset:1248
    v_fmac_f32 v164, v236, v160
    v_fmac_f32 v157, v236, v153
    v_fmac_f32 v165, v236, v161
    s_waitcnt lgkmcnt(7)
    v_mfma_f32_32x32x16_bf16 v[120:135], v[212:215], v[68:71], v[120:135]
    ds_read_b128 v[212:215], v7 offset:2432
    v_fmac_f32 v158, v236, v154
    v_fmac_f32 v166, v236, v162
    v_fmac_f32 v159, v236, v155
    v_fmac_f32 v167, v236, v163
    s_waitcnt lgkmcnt(7)
    v_mfma_f32_32x32x16_bf16 v[120:135], v[200:203], v[72:75], v[120:135]
    ds_read_b128 v[200:203], v7 offset:2560
    v_fmac_f32 v156, v238, v184
    v_fmac_f32 v164, v238, v192
    v_fmac_f32 v157, v238, v185
    s_waitcnt lgkmcnt(7)
    v_mfma_f32_32x32x16_bf16 v[120:135], v[204:207], v[76:79], v[120:135]
    ds_read_b128 v[204:207], v7 offset:2688
    v_fmac_f32 v165, v238, v193
    v_fmac_f32 v158, v238, v186
    v_fmac_f32 v166, v238, v194
    v_fmac_f32 v159, v238, v187
    s_waitcnt lgkmcnt(7)
    v_mfma_f32_32x32x16_bf16 v[120:135], v[208:211], v[80:83], v[120:135]
    ds_read_b128 v[208:211], v7 offset:2816
    v_fmac_f32 v167, v238, v195
    v_mul_f32 v156, v156, v164
    v_mul_f32 v157, v157, v165
    s_waitcnt lgkmcnt(3)
    v_mfma_f32_32x32x16_bf16 v[120:135], v[212:215], v[84:87], v[120:135]
    ds_read_b128 v[212:215], v7 offset:2944
    v_mul_f32 v158, v158, v166
    v_mul_f32 v159, v159, v167
    v_cvt_pk_bf16_f32 v240, v156, v157
    v_cvt_pk_bf16_f32 v241, v158, v159
    s_waitcnt lgkmcnt(3)
    v_mfma_f32_32x32x16_bf16 v[120:135], v[200:203], v[88:91], v[120:135]
    ds_read_b128 v[200:203], v7 offset:3072
    s_waitcnt lgkmcnt(6)
    v_fmac_f32 v220, v236, v216
    ds_read_b128 v[152:155], v246 offset:1280
    ds_read_b128 v[156:159], v246 offset:1344
    ds_read_b128 v[160:163], v246 offset:1408
    ds_read_b128 v[164:167], v246 offset:1472
    v_fmac_f32 v228, v236, v224
    s_waitcnt lgkmcnt(7)
    v_mfma_f32_32x32x16_bf16 v[120:135], v[204:207], v[92:95], v[120:135]
    ds_read_b128 v[204:207], v7 offset:3200
    v_fmac_f32 v221, v236, v217
    v_fmac_f32 v229, v236, v225
    v_fmac_f32 v222, v236, v218
    s_waitcnt lgkmcnt(7)
    v_mfma_f32_32x32x16_bf16 v[120:135], v[208:211], v[96:99], v[120:135]
    ds_read_b128 v[208:211], v7 offset:3328
    v_fmac_f32 v230, v236, v226
    v_fmac_f32 v223, v236, v219
    v_fmac_f32 v231, v236, v227
    v_fmac_f32 v220, v238, v188
    s_waitcnt lgkmcnt(7)
    v_mfma_f32_32x32x16_bf16 v[120:135], v[212:215], v[100:103], v[120:135]
    ds_read_b128 v[212:215], v7 offset:3456
    v_fmac_f32 v228, v238, v196
    v_fmac_f32 v221, v238, v189
    v_fmac_f32 v229, v238, v197
    v_fmac_f32 v222, v238, v190
    s_waitcnt lgkmcnt(7)
    v_mfma_f32_32x32x16_bf16 v[120:135], v[200:203], v[104:107], v[120:135]
    ds_read_b128 v[200:203], v7 offset:29184
    v_fmac_f32 v230, v238, v198
    v_fmac_f32 v223, v238, v191
    v_fmac_f32 v231, v238, v199
    s_waitcnt lgkmcnt(3)
    v_mfma_f32_32x32x16_bf16 v[120:135], v[204:207], v[108:111], v[120:135]
    ds_read_b128 v[204:207], v7 offset:29312
    v_mul_f32 v220, v220, v228
    v_mul_f32 v221, v221, v229
    v_mul_f32 v222, v222, v230
    v_mul_f32 v223, v223, v231
    s_waitcnt lgkmcnt(3)
    v_mfma_f32_32x32x16_bf16 v[120:135], v[208:211], v[112:115], v[120:135]
    ds_read_b128 v[208:211], v7 offset:29440
    v_cvt_pk_bf16_f32 v242, v220, v221
    v_cvt_pk_bf16_f32 v243, v222, v223
    global_store_dwordx4 v245, v[240:243], s[50:51] offset:0 sc1
    s_waitcnt lgkmcnt(3)
    v_mfma_f32_32x32x16_bf16 v[120:135], v[212:215], v[116:119], v[120:135]
    ds_read_b128 v[212:215], v7 offset:29568
    v_mov_b32 v4, s61
    v_mov_b32 v5, 1
    ds_write_b32 v4, v5 offset:16
    s_waitcnt lgkmcnt(4)
    v_mfma_f32_32x32x16_bf16 v[136:151], v[200:203], v[8:11], 0
    ds_read_b128 v[200:203], v7 offset:29696
    s_waitcnt lgkmcnt(4)
    v_mfma_f32_32x32x16_bf16 v[136:151], v[204:207], v[12:15], v[136:151]
    ds_read_b128 v[204:207], v7 offset:29824
    s_waitcnt lgkmcnt(4)
    v_mfma_f32_32x32x16_bf16 v[136:151], v[208:211], v[16:19], v[136:151]
    ds_read_b128 v[208:211], v7 offset:29952
    s_waitcnt lgkmcnt(4)
    v_mfma_f32_32x32x16_bf16 v[136:151], v[212:215], v[20:23], v[136:151]
    ds_read_b128 v[212:215], v7 offset:30080
    s_waitcnt lgkmcnt(3)
    v_mfma_f32_32x32x16_bf16 v[136:151], v[200:203], v[24:27], v[136:151]
    ds_read_b128 v[200:203], v7 offset:30208
    s_waitcnt lgkmcnt(3)
    v_mfma_f32_32x32x16_bf16 v[136:151], v[204:207], v[28:31], v[136:151]
    ds_read_b128 v[204:207], v7 offset:30336
    s_waitcnt lgkmcnt(3)
    v_mfma_f32_32x32x16_bf16 v[136:151], v[208:211], v[32:35], v[136:151]
    ds_read_b128 v[208:211], v7 offset:30464
    s_add_u32 s3, s63, 4
    v_mov_b32 v3, s3
    s_waitcnt vmcnt(1)
    s_mov_b64 exec, 1
    global_store_dword v2, v3, s[50:51] sc1
    s_mov_b64 exec, -1
    s_waitcnt lgkmcnt(15)
    v_fmac_f32 v156, v236, v152
    ds_read_b128 v[216:219], v246 offset:1312
    ds_read_b128 v[220:223], v246 offset:1376
    ds_read_b128 v[224:227], v246 offset:1440
    ds_read_b128 v[228:231], v246 offset:1504
    v_fmac_f32 v164, v236, v160
    v_fmac_f32 v157, v236, v153
    v_fmac_f32 v165, v236, v161
    v_fmac_f32 v158, v236, v154
    v_fmac_f32 v166, v236, v162
    s_waitcnt lgkmcnt(7)
    v_mfma_f32_32x32x16_bf16 v[136:151], v[212:215], v[36:39], v[136:151]
    ds_read_b128 v[212:215], v7 offset:30592
    v_fmac_f32 v159, v236, v155
    v_fmac_f32 v167, v236, v163
    s_waitcnt lgkmcnt(7)
    v_mfma_f32_32x32x16_bf16 v[136:151], v[200:203], v[40:43], v[136:151]
    ds_read_b128 v[200:203], v7 offset:30720
    v_fmac_f32 v156, v238, v120
    v_fmac_f32 v164, v238, v128
    s_waitcnt lgkmcnt(7)
    v_mfma_f32_32x32x16_bf16 v[136:151], v[204:207], v[44:47], v[136:151]
    ds_read_b128 v[204:207], v7 offset:30848
    v_fmac_f32 v157, v238, v121
    v_fmac_f32 v165, v238, v129
    s_waitcnt lgkmcnt(7)
    v_mfma_f32_32x32x16_bf16 v[136:151], v[208:211], v[48:51], v[136:151]
    ds_read_b128 v[208:211], v7 offset:30976
    v_fmac_f32 v158, v238, v122
    v_fmac_f32 v166, v238, v130
    s_waitcnt lgkmcnt(3)
    v_mfma_f32_32x32x16_bf16 v[136:151], v[212:215], v[52:55], v[136:151]
    ds_read_b128 v[212:215], v7 offset:31104
    v_fmac_f32 v159, v238, v123
    v_fmac_f32 v167, v238, v131
    s_waitcnt lgkmcnt(3)
    v_mfma_f32_32x32x16_bf16 v[136:151], v[200:203], v[56:59], v[136:151]
    ds_read_b128 v[200:203], v7 offset:31232
    v_mul_f32 v156, v156, v164
    v_mul_f32 v157, v157, v165
    s_waitcnt lgkmcnt(3)
    v_mfma_f32_32x32x16_bf16 v[136:151], v[204:207], v[60:63], v[136:151]
    ds_read_b128 v[204:207], v7 offset:31360
    v_mul_f32 v158, v158, v166
    v_mul_f32 v159, v159, v167
    v_cvt_pk_bf16_f32 v240, v156, v157
    s_waitcnt lgkmcnt(3)
    v_mfma_f32_32x32x16_bf16 v[136:151], v[208:211], v[64:67], v[136:151]
    ds_read_b128 v[208:211], v7 offset:31488
    v_cvt_pk_bf16_f32 v241, v158, v159
    s_waitcnt lgkmcnt(8)
    s_waitcnt lgkmcnt(3)
    v_mfma_f32_32x32x16_bf16 v[136:151], v[212:215], v[68:71], v[136:151]
    ds_read_b128 v[212:215], v7 offset:31616
    v_fmac_f32 v220, v236, v216
    ds_read_b128 v[152:155], v246 offset:1536
    ds_read_b128 v[156:159], v246 offset:1600
    ds_read_b128 v[160:163], v246 offset:1664
    ds_read_b128 v[164:167], v246 offset:1728
    s_waitcnt lgkmcnt(7)
    v_mfma_f32_32x32x16_bf16 v[136:151], v[200:203], v[72:75], v[136:151]
    ds_read_b128 v[200:203], v7 offset:31744
    v_fmac_f32 v228, v236, v224
    v_fmac_f32 v221, v236, v217
    s_waitcnt lgkmcnt(7)
    v_mfma_f32_32x32x16_bf16 v[136:151], v[204:207], v[76:79], v[136:151]
    ds_read_b128 v[204:207], v7 offset:31872
    v_fmac_f32 v229, v236, v225
    v_fmac_f32 v222, v236, v218
    s_waitcnt lgkmcnt(7)
    v_mfma_f32_32x32x16_bf16 v[136:151], v[208:211], v[80:83], v[136:151]
    ds_read_b128 v[208:211], v7 offset:32000
    v_fmac_f32 v230, v236, v226
    v_fmac_f32 v223, v236, v219
    s_waitcnt lgkmcnt(7)
    v_mfma_f32_32x32x16_bf16 v[136:151], v[212:215], v[84:87], v[136:151]
    ds_read_b128 v[212:215], v7 offset:32128
    v_fmac_f32 v231, v236, v227
    v_fmac_f32 v220, v238, v124
    s_waitcnt lgkmcnt(3)
    v_mfma_f32_32x32x16_bf16 v[136:151], v[200:203], v[88:91], v[136:151]
    ds_read_b128 v[200:203], v7 offset:32256
    v_fmac_f32 v228, v238, v132
    v_fmac_f32 v221, v238, v125
    s_waitcnt lgkmcnt(3)
    v_mfma_f32_32x32x16_bf16 v[136:151], v[204:207], v[92:95], v[136:151]
    ds_read_b128 v[204:207], v7 offset:32384
    v_fmac_f32 v229, v238, v133
    v_fmac_f32 v222, v238, v126
    s_waitcnt lgkmcnt(3)
    v_mfma_f32_32x32x16_bf16 v[136:151], v[208:211], v[96:99], v[136:151]
    ds_read_b128 v[208:211], v7 offset:32512
    v_fmac_f32 v230, v238, v134
    v_fmac_f32 v223, v238, v127
    s_waitcnt lgkmcnt(3)
    v_mfma_f32_32x32x16_bf16 v[136:151], v[212:215], v[100:103], v[136:151]
    ds_read_b128 v[212:215], v7 offset:32640
    v_fmac_f32 v231, v238, v135
    v_mul_f32 v220, v220, v228
    s_waitcnt lgkmcnt(3)
    v_mfma_f32_32x32x16_bf16 v[136:151], v[200:203], v[104:107], v[136:151]
    v_mul_f32 v221, v221, v229
    v_mul_f32 v222, v222, v230
    s_waitcnt lgkmcnt(2)
    v_mfma_f32_32x32x16_bf16 v[136:151], v[204:207], v[108:111], v[136:151]
    v_mul_f32 v223, v223, v231
    v_cvt_pk_bf16_f32 v242, v220, v221
    s_waitcnt lgkmcnt(1)
    v_mfma_f32_32x32x16_bf16 v[136:151], v[208:211], v[112:115], v[136:151]
    v_cvt_pk_bf16_f32 v243, v222, v223
    global_store_dwordx4 v245, v[240:243], s[50:51] offset:1024 sc1
    s_waitcnt lgkmcnt(0)
    v_mfma_f32_32x32x16_bf16 v[136:151], v[212:215], v[116:119], v[136:151]
    s_waitcnt lgkmcnt(8)
    v_fmac_f32 v156, v236, v152
    ds_read_b128 v[216:219], v246 offset:1568
    ds_read_b128 v[220:223], v246 offset:1632
    ds_read_b128 v[224:227], v246 offset:1696
    ds_read_b128 v[228:231], v246 offset:1760
    v_fmac_f32 v164, v236, v160
    v_fmac_f32 v157, v236, v153
    v_fmac_f32 v165, v236, v161
    v_fmac_f32 v158, v236, v154
    v_fmac_f32 v166, v236, v162
    v_fmac_f32 v159, v236, v155
    v_fmac_f32 v167, v236, v163
    v_fmac_f32 v156, v238, v136
    v_fmac_f32 v164, v238, v144
    v_fmac_f32 v157, v238, v137
    v_fmac_f32 v165, v238, v145
    v_fmac_f32 v158, v238, v138
    v_fmac_f32 v166, v238, v146
    v_fmac_f32 v159, v238, v139
    v_fmac_f32 v167, v238, v147
    v_mul_f32 v156, v156, v164
    v_mul_f32 v157, v157, v165
    v_mul_f32 v158, v158, v166
    v_mul_f32 v159, v159, v167
    v_cvt_pk_bf16_f32 v240, v156, v157
    v_cvt_pk_bf16_f32 v241, v158, v159
    s_waitcnt lgkmcnt(0)
    v_fmac_f32 v220, v236, v216
    v_fmac_f32 v228, v236, v224
    v_fmac_f32 v221, v236, v217
    v_fmac_f32 v229, v236, v225
    v_fmac_f32 v222, v236, v218
    v_fmac_f32 v230, v236, v226
    v_fmac_f32 v223, v236, v219
    v_fmac_f32 v231, v236, v227
    v_fmac_f32 v220, v238, v140
    v_fmac_f32 v228, v238, v148
    v_fmac_f32 v221, v238, v141
    v_fmac_f32 v229, v238, v149
    v_fmac_f32 v222, v238, v142
    v_fmac_f32 v230, v238, v150
    v_fmac_f32 v223, v238, v143
    v_fmac_f32 v231, v238, v151
    v_mul_f32 v220, v220, v228
    v_mul_f32 v221, v221, v229
    v_mul_f32 v222, v222, v230
    v_mul_f32 v223, v223, v231
    v_cvt_pk_bf16_f32 v242, v220, v221
    v_cvt_pk_bf16_f32 v243, v222, v223
    global_store_dwordx4 v245, v[240:243], s[50:51] offset:2048 sc1
    s_add_u32 s3, s63, 7
    v_mov_b32 v3, s3
    s_waitcnt vmcnt(0)
    s_mov_b64 exec, 1
    global_store_dword v2, v3, s[50:51] sc1
    s_mov_b64 exec, -1
    s_cmp_lt_u32 s5, 28
    s_cbranch_scc0 L_nohw
    s_lshr_b32 s15, s18, 1
    s_lshl_b32 s15, s15, 6
    s_and_b32 s3, s18, 1
    s_lshl_b32 s3, s3, 1
    s_add_u32 s15, s15, s3
    v_bfe_u32 v2, v1, 1, 4
    v_and_b32 v3, 1, v1
    v_lshl_add_u32 v2, v2, 2, v3
    v_add_u32 v2, s15, v2
    v_lshlrev_b32 v2, 7, v2
    v_add_u32 v2, 262144, v2
    s_cmp_eq_u32 s6, 0
    s_cbranch_scc0 L_nohw
    s_mov_b32 s64, 0
poll_17:
    global_load_dword v3, v2, s[50:51] sc1
    s_waitcnt vmcnt(0)
    v_subrev_u32 v3, s63, v3
    v_cmp_ne_u32 vcc, 7, v3
    s_cbranch_vccz pdone_18
    s_add_u32 s64, s64, 1
    s_cmp_lt_u32 s64, 20000
    s_sleep 1
    s_cbranch_scc1 poll_17
pdone_18:
    v_mov_b32 v242, 161052
    v_mov_b32 v243, 1
    ds_write_b32 v242, v243
L_nohw:
    s_branch L_fin
L_g1:
    s_mul_i32 s11, s4, 21
    s_add_u32 s11, s11, s5
    s_cmp_ge_u32 s6, 6
    s_cbranch_scc0 L_nopf
    s_getpc_b64 s[8:9]
L_pc:
    s_sub_u32 s8, s8, L_pc-adaLN_cond__ssm_conv_s4__glu_gated_bilinear__prompt_kernel
    s_subb_u32 s9, s9, 0
    s_sub_u32 s15, s6, 6
    s_lshl_b32 s15, s15, 5
    s_add_u32 s15, s15, s5
    s_lshl_b32 s15, s15, 10
    v_lshl_add_u32 v2, v1, 4, s15
    v_min_u32 v2, L_code_end-adaLN_cond__ssm_conv_s4__glu_gated_bilinear__prompt_kernel-16, v2
    global_load_dwordx4 v[22:25], v2, s[8:9]
L_nopf:
    v_mov_b32 v26, 0
    v_mov_b32 v27, 0
    v_mov_b32 v28, 0
    v_mov_b32 v29, 0
    v_mov_b32 v48, 0
    v_mov_b32 v49, 0
    v_mov_b32 v50, 0
    v_mov_b32 v51, 0
    v_mov_b32 v52, 0
    v_mov_b32 v53, 0
    v_mov_b32 v54, 0
    v_mov_b32 v55, 0
    s_and_b32 s3, s11, 3
    s_mul_i32 s3, s3, 112
    v_lshrrev_b32 v30, 3, v0
    v_add_u32 v30, s3, v30
    v_lshlrev_b32 v31, 1, v30
    v_mul_u32_u24 v30, 5376, v30
    v_and_b32 v4, 7, v0
    v_lshlrev_b32 v4, 4, v4
    s_lshr_b32 s15, s11, 2
    s_lshl_b32 s15, s15, 7
    v_add3_u32 v30, v30, v4, s15
    v_and_b32 v4, 3, v0
    v_mul_u32_u24 v72, 1792, v4
    v_and_b32 v2, 252, v0
    s_mul_i32 s3, s2, 7168
    v_add3_u32 v72, v72, v2, s3
    s_lshl_b32 s15, s6, 1
    s_sub_u32 s15, s15, 8
    s_mul_i32 s15, s15, 896
    s_add_u32 s3, s3, s15
    v_lshl_add_u32 v5, v1, 4, s3
    s_cmp_lt_u32 s6, 6
    s_movk_i32 s15, 512
    s_cselect_b32 s15, 768, s15
    v_add_u32 v73, s15, v72
    s_cselect_b32 s9, 0, 0x40000000
    s_cmp_lt_u32 s5, 21
    s_cselect_b32 s8, 0, 0x40000000
    s_or_b32 s9, s9, s8
    s_and_b32 s3, s10, 3
    s_mul_i32 s3, s3, 401408
    s_lshr_b32 s15, s10, 3
    s_lshl_b32 s15, s15, 7
    s_add_u32 s15, s15, s3
    v_lshrrev_b32 v74, 4, v0
    v_min_u32 v74, 13, v74
    v_mul_u32_u24 v74, 28672, v74
    v_and_b32 v3, 15, v0
    v_lshlrev_b32 v3, 3, v3
    v_add3_u32 v74, v74, v3, s15
    s_waitcnt lgkmcnt(0)
    s_mov_b32 s52, s44
    s_mov_b32 s53, s45
    s_mov_b32 s54, 2408448
    s_mov_b32 s55, 0x20000
    s_mov_b32 s56, s42
    s_mov_b32 s57, s43
    s_mov_b32 s58, 896
    s_mov_b32 s59, 0x20000
    s_add_u32 s3, s8, 0
    buffer_load_dwordx4 v[32:35], v30, s[52:55], s3 offen nt
    s_add_u32 s3, s8, 172032
    buffer_load_dwordx4 v[36:39], v30, s[52:55], s3 offen nt
    s_add_u32 s3, s8, 344064
    buffer_load_dwordx4 v[40:43], v30, s[52:55], s3 offen nt
    s_add_u32 s3, s9, 516096
    buffer_load_dwordx4 v[44:47], v30, s[52:55], s3 offen nt
    buffer_load_short_d16_hi v26, v31, s[56:59], s8 offen offset:0
    buffer_load_short_d16_hi v27, v31, s[56:59], s8 offen offset:64
    buffer_load_short_d16_hi v28, v31, s[56:59], s8 offen offset:128
    buffer_load_short_d16_hi v29, v31, s[56:59], s9 offen offset:192
    global_load_dword v56, v72, s[16:17] offset:0 nt
    global_load_dword v58, v72, s[16:17] offset:896 nt
    global_load_dword v60, v72, s[16:17] offset:256 nt
    global_load_dword v62, v72, s[16:17] offset:1152 nt
    global_load_dword v64, v72, s[16:17] offset:512 nt
    global_load_dword v66, v72, s[16:17] offset:1408 nt
    global_load_dword v68, v73, s[16:17] offset:0 nt
    global_load_dword v70, v73, s[16:17] offset:896 nt
    s_mov_b32 exec_hi, 0x00ffffff
    global_load_dwordx4 v[48:51], v5, s[16:17] nt
    global_load_dwordx4 v[52:55], v5, s[16:17] offset:896 nt
    s_mov_b32 exec_hi, -1
    s_load_dword s7, s[50:51], 0
    s_barrier
    s_bitcmp1_b32 s10, 2
    s_cselect_b32 s60, s38, s36
    s_cselect_b32 s61, s39, s37
    s_mov_b32 s62, 1605632
    s_mov_b32 s63, 0x20000
    s_mul_i32 s3, s2, 14336
    s_add_u32 s3, s3, 17301504
    v_lshl_add_u32 v76, v0, 4, s3
    v_add_u32 v77, 4096, v76
    v_add_u32 v78, 8192, v76
    s_cmp_lt_u32 s6, 6
    s_movk_i32 s3, 8192
    s_cselect_b32 s3, 12288, s3
    v_add_u32 v79, s3, v76
    v_and_b32 v75, 7, v1
    v_lshlrev_b32 v75, 5, v75
    v_lshrrev_b32 v3, 5, v1
    v_lshl_add_u32 v75, v3, 4, v75
    v_bfe_u32 v3, v1, 4, 1
    v_lshl_add_u32 v75, v3, 3, v75
    s_lshl_b32 s3, s6, 8
    s_add_u32 s3, s3, 154368
    v_add_u32 v75, s3, v75
    s_waitcnt lgkmcnt(0)
    s_add_u32 s7, s7, 1
    v_mov_b32 v57, s7
    v_mov_b32 v59, s7
    v_mov_b32 v61, s7
    v_mov_b32 v63, s7
    v_mov_b32 v65, s7
    v_mov_b32 v67, s7
    v_mov_b32 v69, s7
    v_mov_b32 v71, s7
    s_setprio 2
    s_waitcnt vmcnt(10)
    s_cmp_lt_u32 s5, 21
    s_cbranch_scc0 L_nog1
    v_mul_f32 v2, 0xbfb8aa3b, v26
    v_mul_f32 v3, 0xbfb8aa3b, v27
    v_mul_f32 v4, 0xbfb8aa3b, v28
    v_mul_f32 v5, 0xbfb8aa3b, v29
    v_exp_f32 v2, v2
    v_exp_f32 v3, v3
    v_exp_f32 v4, v4
    v_exp_f32 v5, v5
    v_add_f32 v2, 1.0, v2
    v_add_f32 v3, 1.0, v3
    v_add_f32 v4, 1.0, v4
    v_add_f32 v5, 1.0, v5
    v_rcp_f32 v2, v2
    v_rcp_f32 v3, v3
    v_rcp_f32 v4, v4
    v_rcp_f32 v5, v5
    v_lshlrev_b32 v84, 16, v32
    v_and_b32 v85, 0xffff0000, v32
    v_lshlrev_b32 v86, 16, v33
    v_and_b32 v87, 0xffff0000, v33
    v_lshlrev_b32 v88, 16, v34
    v_and_b32 v89, 0xffff0000, v34
    v_lshlrev_b32 v90, 16, v35
    v_and_b32 v91, 0xffff0000, v35
    v_mul_f32 v2, v2, v26
    v_mul_f32 v3, v3, v27
    v_mul_f32 v4, v4, v28
    v_mul_f32 v5, v5, v29
    v_cvt_pk_bf16_f32 v2, v2, v3
    v_lshlrev_b32 v26, 16, v2
    v_and_b32 v27, 0xffff0000, v2
    v_cvt_pk_bf16_f32 v4, v4, v5
    v_lshlrev_b32 v28, 16, v4
    v_and_b32 v29, 0xffff0000, v4
    v_pk_mul_f32 v[84:85], v[84:85], v[26:27] op_sel:[0,0] op_sel_hi:[1,0]
    v_pk_mul_f32 v[86:87], v[86:87], v[26:27] op_sel:[0,0] op_sel_hi:[1,0]
    v_pk_mul_f32 v[88:89], v[88:89], v[26:27] op_sel:[0,0] op_sel_hi:[1,0]
    v_pk_mul_f32 v[90:91], v[90:91], v[26:27] op_sel:[0,0] op_sel_hi:[1,0]
    v_lshlrev_b32 v2, 16, v36
    v_and_b32 v3, 0xffff0000, v36
    v_pk_fma_f32 v[84:85], v[2:3], v[26:27], v[84:85] op_sel:[0,1,0] op_sel_hi:[1,1,1]
    v_lshlrev_b32 v4, 16, v37
    v_and_b32 v5, 0xffff0000, v37
    v_pk_fma_f32 v[86:87], v[4:5], v[26:27], v[86:87] op_sel:[0,1,0] op_sel_hi:[1,1,1]
    v_lshlrev_b32 v2, 16, v38
    v_and_b32 v3, 0xffff0000, v38
    v_pk_fma_f32 v[88:89], v[2:3], v[26:27], v[88:89] op_sel:[0,1,0] op_sel_hi:[1,1,1]
    v_lshlrev_b32 v4, 16, v39
    v_and_b32 v5, 0xffff0000, v39
    v_pk_fma_f32 v[90:91], v[4:5], v[26:27], v[90:91] op_sel:[0,1,0] op_sel_hi:[1,1,1]
    v_lshlrev_b32 v2, 16, v40
    v_and_b32 v3, 0xffff0000, v40
    v_pk_fma_f32 v[84:85], v[2:3], v[28:29], v[84:85] op_sel:[0,0,0] op_sel_hi:[1,0,1]
    v_lshlrev_b32 v4, 16, v41
    v_and_b32 v5, 0xffff0000, v41
    v_pk_fma_f32 v[86:87], v[4:5], v[28:29], v[86:87] op_sel:[0,0,0] op_sel_hi:[1,0,1]
    v_lshlrev_b32 v2, 16, v42
    v_and_b32 v3, 0xffff0000, v42
    v_pk_fma_f32 v[88:89], v[2:3], v[28:29], v[88:89] op_sel:[0,0,0] op_sel_hi:[1,0,1]
    v_lshlrev_b32 v4, 16, v43
    v_and_b32 v5, 0xffff0000, v43
    v_pk_fma_f32 v[90:91], v[4:5], v[28:29], v[90:91] op_sel:[0,0,0] op_sel_hi:[1,0,1]
    v_lshlrev_b32 v2, 16, v44
    v_and_b32 v3, 0xffff0000, v44
    v_pk_fma_f32 v[84:85], v[2:3], v[28:29], v[84:85] op_sel:[0,1,0] op_sel_hi:[1,1,1]
    v_lshlrev_b32 v4, 16, v45
    v_and_b32 v5, 0xffff0000, v45
    v_pk_fma_f32 v[86:87], v[4:5], v[28:29], v[86:87] op_sel:[0,1,0] op_sel_hi:[1,1,1]
    v_lshlrev_b32 v2, 16, v46
    v_and_b32 v3, 0xffff0000, v46
    v_pk_fma_f32 v[88:89], v[2:3], v[28:29], v[88:89] op_sel:[0,1,0] op_sel_hi:[1,1,1]
    v_lshlrev_b32 v4, 16, v47
    v_and_b32 v5, 0xffff0000, v47
    v_pk_fma_f32 v[90:91], v[4:5], v[28:29], v[90:91] op_sel:[0,1,0] op_sel_hi:[1,1,1]
    v_permlane32_swap_b32 v84, v88
    v_permlane32_swap_b32 v85, v89
    v_permlane32_swap_b32 v86, v90
    v_permlane32_swap_b32 v87, v91
    v_add_f32 v84, v84, v88
    v_add_f32 v85, v85, v89
    v_add_f32 v86, v86, v90
    v_add_f32 v87, v87, v91
    s_nop 0
    v_permlane16_swap_b32 v84, v86
    v_permlane16_swap_b32 v85, v87
    v_add_f32 v84, v84, v86
    v_add_f32 v85, v85, v87
    s_nop 0
    v_add_f32_dpp v84, v84, v84 row_ror:8 row_mask:0xf bank_mask:0xf
    v_add_f32_dpp v85, v85, v85 row_ror:8 row_mask:0xf bank_mask:0xf
    ds_write_b64 v75, v[84:85]
L_nog1:
    s_waitcnt vmcnt(0)
    global_store_dwordx4 v76, v[56:59], s[50:51] sc1
    global_store_dwordx4 v77, v[60:63], s[50:51] sc1
    global_store_dwordx4 v78, v[64:67], s[50:51] sc1
    global_store_dwordx4 v79, v[68:71], s[50:51] sc1
    v_mov_b32 v84, 0
    v_mov_b32 v85, 0
    v_mov_b32 v86, 0
    v_mov_b32 v87, 0
    v_dot2c_f32_bf16 v84, 0x3f803f80, v48
    v_dot2c_f32_bf16 v85, v48, v48
    v_dot2c_f32_bf16 v86, 0x3f803f80, v52
    v_dot2c_f32_bf16 v87, v52, v52
    v_dot2c_f32_bf16 v84, 0x3f803f80, v49
    v_dot2c_f32_bf16 v85, v49, v49
    v_dot2c_f32_bf16 v86, 0x3f803f80, v53
    v_dot2c_f32_bf16 v87, v53, v53
    v_dot2c_f32_bf16 v84, 0x3f803f80, v50
    v_dot2c_f32_bf16 v85, v50, v50
    v_dot2c_f32_bf16 v86, 0x3f803f80, v54
    v_dot2c_f32_bf16 v87, v54, v54
    v_dot2c_f32_bf16 v84, 0x3f803f80, v51
    v_dot2c_f32_bf16 v85, v51, v51
    v_dot2c_f32_bf16 v86, 0x3f803f80, v55
    v_dot2c_f32_bf16 v87, v55, v55
    v_add_f32_dpp v84, v84, v84 row_shr:1 row_mask:0xf bank_mask:0xf
    v_add_f32_dpp v85, v85, v85 row_shr:1 row_mask:0xf bank_mask:0xf
    v_add_f32_dpp v86, v86, v86 row_shr:1 row_mask:0xf bank_mask:0xf
    v_add_f32_dpp v87, v87, v87 row_shr:1 row_mask:0xf bank_mask:0xf
    v_add_f32_dpp v84, v84, v84 row_shr:2 row_mask:0xf bank_mask:0xf
    v_add_f32_dpp v85, v85, v85 row_shr:2 row_mask:0xf bank_mask:0xf
    v_add_f32_dpp v86, v86, v86 row_shr:2 row_mask:0xf bank_mask:0xf
    v_add_f32_dpp v87, v87, v87 row_shr:2 row_mask:0xf bank_mask:0xf
    v_add_f32_dpp v84, v84, v84 row_shr:4 row_mask:0xf bank_mask:0xf
    v_add_f32_dpp v85, v85, v85 row_shr:4 row_mask:0xf bank_mask:0xf
    v_add_f32_dpp v86, v86, v86 row_shr:4 row_mask:0xf bank_mask:0xf
    v_add_f32_dpp v87, v87, v87 row_shr:4 row_mask:0xf bank_mask:0xf
    v_add_f32_dpp v84, v84, v84 row_shr:8 row_mask:0xf bank_mask:0xf
    v_add_f32_dpp v85, v85, v85 row_shr:8 row_mask:0xf bank_mask:0xf
    v_add_f32_dpp v86, v86, v86 row_shr:8 row_mask:0xf bank_mask:0xf
    v_add_f32_dpp v87, v87, v87 row_shr:8 row_mask:0xf bank_mask:0xf
    v_add_f32_dpp v84, v84, v84 row_bcast:15 row_mask:0xa bank_mask:0xf
    v_add_f32_dpp v85, v85, v85 row_bcast:15 row_mask:0xa bank_mask:0xf
    v_add_f32_dpp v86, v86, v86 row_bcast:15 row_mask:0xa bank_mask:0xf
    v_add_f32_dpp v87, v87, v87 row_bcast:15 row_mask:0xa bank_mask:0xf
    v_add_f32_dpp v84, v84, v84 row_bcast:31 row_mask:0xc bank_mask:0xf
    v_add_f32_dpp v85, v85, v85 row_bcast:31 row_mask:0xc bank_mask:0xf
    v_add_f32_dpp v86, v86, v86 row_bcast:31 row_mask:0xc bank_mask:0xf
    v_add_f32_dpp v87, v87, v87 row_bcast:31 row_mask:0xc bank_mask:0xf
    v_mul_f32 v84, 0x3b124925, v84
    v_mul_f32 v85, 0x3b124925, v85
    v_fma_f32 v85, -v84, v84, v85
    v_max_f32 v85, 0, v85
    v_cvt_pk_bf16_f32 v85, v85, v85
    v_and_b32 v85, 0xffff0000, v85
    v_add_f32 v85, 0x3727c5ac, v85
    v_cvt_pk_bf16_f32 v85, v85, v85
    v_and_b32 v85, 0xffff0000, v85
    v_sqrt_f32 v85, v85
    v_mul_f32 v86, 0x3b124925, v86
    v_mul_f32 v87, 0x3b124925, v87
    v_fma_f32 v87, -v86, v86, v87
    v_max_f32 v87, 0, v87
    v_cvt_pk_bf16_f32 v87, v87, v87
    v_and_b32 v87, 0xffff0000, v87
    v_add_f32 v87, 0x3727c5ac, v87
    v_cvt_pk_bf16_f32 v87, v87, v87
    v_and_b32 v87, 0xffff0000, v87
    v_sqrt_f32 v87, v87
    s_lshl_b32 s3, s6, 3
    s_add_u32 s3, s3, 160480
    v_mov_b32 v2, s3
    v_cvt_pk_bf16_f32 v84, v84, v85
    v_cvt_pk_bf16_f32 v85, v86, v87
    s_mov_b32 exec_lo, 0
    s_mov_b32 exec_hi, 0x80000000
    ds_write_b64 v2, v[84:85]
    s_mov_b64 exec, -1
    s_sub_u32 s15, s6, 4
    s_lshl_b32 s3, s15, 2
    s_add_u32 s3, s3, 160832
    v_mov_b32 v2, s3
    v_mov_b32 v3, 1
    ds_write_b32 v2, v3
    s_cmp_lt_u32 s6, 6
    s_cbranch_scc0 L_nofin
    s_mov_b32 s64, 0
    v_mov_b32 v2, 160832
lf_20:
    ds_read_b128 v[32:35], v2
    s_waitcnt lgkmcnt(0)
    v_and_b32 v32, v32, v33
    v_and_b32 v34, v34, v35
    v_and_b32 v32, v32, v34
    v_cmp_eq_u32 vcc, 0, v32
    s_cbranch_vccz lfd_21
    s_add_u32 s64, s64, 1
    s_cmp_lt_u32 s64, 400000
    s_cbranch_scc1 lf_20
lfd_21:
    s_cmp_eq_u32 s6, 5
    s_cbranch_scc1 L_stfin
    s_cmp_lt_u32 s5, 21
    s_cbranch_scc0 L_nofin
    v_lshlrev_b32 v2, 2, v1
    v_add_u32 v2, 155392, v2
    ds_read_b32 v32, v2 offset:0
    ds_read_b32 v34, v2 offset:256
    ds_read_b32 v36, v2 offset:512
    ds_read_b32 v38, v2 offset:768
    s_and_b32 s3, s11, 3
    s_mul_i32 s3, s3, 21504
    s_lshr_b32 s15, s11, 2
    s_lshl_b32 s15, s15, 9
    s_add_u32 s3, s3, s15
    s_add_u32 s3, s3, 163840
    v_lshl_add_u32 v2, v1, 3, s3
    v_mov_b32 v33, s7
    s_waitcnt lgkmcnt(0)
    v_add_f32 v32, v32, v34
    v_add_f32 v36, v36, v38
    v_add_f32 v32, v32, v36
    global_store_dwordx2 v2, v[32:33], s[50:51] sc1
    s_branch L_nofin
L_stfin:
    v_lshlrev_b32 v2, 2, v1
    v_add_u32 v2, 160512, v2
    s_mov_b64 exec, 0xff
    ds_read_b32 v32, v2
    v_mov_b32 v33, s7
    s_lshl_b32 s3, s2, 6
    s_add_u32 s3, s3, 4096
    v_lshl_add_u32 v2, v1, 3, s3
    s_waitcnt lgkmcnt(0)
    global_store_dwordx2 v2, v[32:33], s[50:51] sc1
    s_mov_b64 exec, -1
L_nofin:
    s_setprio 0
    s_cmp_lt_u32 s5, 28
    s_cbranch_scc0 L_norp
    buffer_load_dwordx2 v[6:7], v74, s[60:63], 0 offen nt
    s_mov_b32 s3, 3584
    buffer_load_dwordx2 v[8:9], v74, s[60:63], s3 offen nt
    s_mov_b32 s3, 7168
    buffer_load_dwordx2 v[10:11], v74, s[60:63], s3 offen nt
    s_mov_b32 s3, 10752
    buffer_load_dwordx2 v[12:13], v74, s[60:63], s3 offen nt
    s_mov_b32 s3, 14336
    buffer_load_dwordx2 v[14:15], v74, s[60:63], s3 offen nt
    s_mov_b32 s3, 17920
    buffer_load_dwordx2 v[16:17], v74, s[60:63], s3 offen nt
    s_mov_b32 s3, 21504
    buffer_load_dwordx2 v[18:19], v74, s[60:63], s3 offen nt
    s_mov_b32 s3, 25088
    buffer_load_dwordx2 v[20:21], v74, s[60:63], s3 offen nt
    s_mov_b32 s8, 0x05040100
    s_mov_b32 s9, 0x07060302
    s_lshr_b32 s3, s10, 3
    s_mul_i32 s3, s3, 116736
    s_bfe_u32 s15, s10, 0x10002
    s_mul_i32 s15, s15, 14592
    s_add_u32 s3, s3, s15
    s_and_b32 s15, s10, 3
    s_mul_i32 s15, s15, 896
    s_add_u32 s3, s3, s15
    s_add_u32 s3, s3, 4718592
    v_bfe_u32 v4, v0, 2, 2
    v_mul_u32_u24 v4, 29184, v4
    v_lshrrev_b32 v5, 4, v0
    v_lshl_add_u32 v4, v5, 6, v4
    v_cmp_gt_u32 vcc, 14, v5
    v_and_b32 v5, 3, v0
    v_lshlrev_b32 v5, 4, v5
    v_add3_u32 v4, v4, v5, s3
    v_add_u32 v5, 7296, v4
    s_waitcnt vmcnt(0)
    v_perm_b32 v92, v8, v6, s8
    v_perm_b32 v93, v12, v10, s8
    v_perm_b32 v94, v16, v14, s8
    v_perm_b32 v95, v20, v18, s8
    v_perm_b32 v96, v8, v6, s9
    v_perm_b32 v97, v12, v10, s9
    v_perm_b32 v98, v16, v14, s9
    v_perm_b32 v99, v20, v18, s9
    v_perm_b32 v100, v9, v7, s8
    v_perm_b32 v101, v13, v11, s8
    v_perm_b32 v102, v17, v15, s8
    v_perm_b32 v103, v21, v19, s8
    v_perm_b32 v104, v9, v7, s9
    v_perm_b32 v105, v13, v11, s9
    v_perm_b32 v106, v17, v15, s9
    v_perm_b32 v107, v21, v19, s9
    s_mov_b64 s[8:9], vcc
    s_mov_b64 exec, s[8:9]
    global_store_dwordx4 v4, v[92:95], s[50:51] offset:0 sc1
    global_store_dwordx4 v4, v[96:99], s[50:51] offset:3648 sc1
    global_store_dwordx4 v5, v[100:103], s[50:51] offset:0 sc1
    global_store_dwordx4 v5, v[104:107], s[50:51] offset:3648 sc1
    s_mov_b64 exec, -1
L_norp:
    s_lshr_b32 s16, s4, 2
    s_lshl_b32 s16, s16, 3
    s_lshr_b32 s3, s5, 2
    s_add_u32 s16, s16, s3
    s_and_b32 s17, s4, 3
    s_lshl_b32 s17, s17, 2
    s_and_b32 s3, s5, 3
    s_add_u32 s17, s17, s3
    s_mul_i32 s3, s5, 37
    s_lshr_b32 s3, s3, 8
    s_lshl_b32 s18, s4, 2
    s_add_u32 s18, s18, s3
    s_mul_i32 s3, s3, 7
    s_sub_u32 s19, s5, s3
    s_add_u32 s52, s50, 2883584
    s_addc_u32 s53, s51, 0
    s_mov_b32 s54, 1835008
    s_mov_b32 s55, 0x20000
    s_add_u32 s36, s50, 1048576
    s_addc_u32 s37, s51, 0
    s_mov_b32 s38, 1835008
    s_mov_b32 s39, 0x20000
    s_mul_i32 s3, s17, 204288
    s_add_u32 s3, s3, 4718592
    s_add_u32 s56, s50, s3
    s_addc_u32 s57, s51, 0
    s_mov_b32 s58, 204288
    s_mov_b32 s59, 0x20000
    s_mov_b32 s20, s40
    s_mov_b32 s21, s41
    s_mov_b32 s22, 1605632
    s_mov_b32 s23, 0x20000
    s_add_u32 s24, s50, 9830400
    s_addc_u32 s25, s51, 0
    s_mov_b32 s26, 7340032
    s_mov_b32 s27, 0x20000
    s_sub_u32 s64, s6, 4
    v_lshlrev_b32 v23, 4, v1
    v_lshrrev_b32 v2, 5, v1
    v_bfe_u32 v3, v1, 3, 1
    v_lshl_add_u32 v2, v3, 1, v2
    v_mul_u32_u24 v127, 100352, v2
    v_bfe_u32 v2, v1, 4, 1
    v_mul_u32_u24 v2, 896, v2
    v_and_b32 v3, 7, v1
    v_lshlrev_b32 v3, 4, v3
    v_add3_u32 v127, v127, v2, v3
    s_lshl_b32 s15, s19, 7
    s_mul_i32 s3, s64, 401408
    s_add_u32 s15, s15, s3
    v_add_u32 v127, s15, v127
    s_setprio 2
    s_cmp_lt_u32 s5, 28
    s_cbranch_scc0 L_noc
    v_lshrrev_b32 v2, 2, v0
    v_min_u32 v2, 55, v2
    v_and_b32 v4, 3, v0
    v_mul_u32_u24 v4, 21504, v4
    v_lshl_add_u32 v4, v2, 4, v4
    s_and_b32 s3, s10, 3
    s_mul_i32 s3, s3, 896
    s_add_u32 s3, s3, 174592
    v_add_u32 v4, s3, v4
    global_load_dwordx4 v[28:31], v4, s[50:51] sc1
    global_load_dwordx4 v[32:35], v4, s[50:51] offset:3584 sc1
    s_waitcnt vmcnt(2)
    s_lshl_b32 s3, s64, 2
    s_add_u32 s3, s3, 160992
    v_mov_b32 v3, s3
    v_mov_b32 v5, 1
    ds_write_b32 v3, v5
    s_cmp_eq_u32 s6, 4
    s_cbranch_scc0 L_nowf
    s_mov_b32 s65, 0
    v_mov_b32 v3, 160992
lf_22:
    ds_read_b128 v[76:79], v3
    s_waitcnt lgkmcnt(0)
    v_and_b32 v76, v76, v77
    v_and_b32 v78, v78, v79
    v_and_b32 v76, v76, v78
    v_cmp_eq_u32 vcc, 0, v76
    s_cbranch_vccz lfd_23
    s_add_u32 s65, s65, 1
    s_cmp_lt_u32 s65, 400000
    s_cbranch_scc1 lf_22
lfd_23:
    s_lshl_b32 s15, s10, 7
    s_add_u32 s15, s15, 131072
    v_mov_b32 v3, s15
    v_mov_b32 v5, s7
    s_mov_b64 exec, 1
    global_store_dword v3, v5, s[50:51] sc1
    s_mov_b64 exec, -1
L_nowf:
    s_mov_b32 s65, 0
    s_branch pskip_26
poll_24:
    global_load_dwordx4 v[28:31], v4, s[50:51] sc1
    global_load_dwordx4 v[32:35], v4, s[50:51] offset:3584 sc1
pskip_26:
    s_waitcnt vmcnt(0)
    v_xor_b32 v29, s7, v29
    v_xor_b32 v31, s7, v31
    v_xor_b32 v33, s7, v33
    v_xor_b32 v35, s7, v35
    v_or3_b32 v29, v29, v31, v33
    v_or_b32 v29, v29, v35
    v_cmp_ne_u32 vcc, 0, v29
    s_cbranch_vccz pdone_25
    s_add_u32 s65, s65, 1
    s_cmp_lt_u32 s65, 20000
    s_sleep 2
    s_cbranch_scc1 poll_24
pdone_25:
    v_add_f32_dpp v28, v28, v28 quad_perm:[1,0,3,2] row_mask:0xf bank_mask:0xf
    v_add_f32_dpp v30, v30, v30 quad_perm:[1,0,3,2] row_mask:0xf bank_mask:0xf
    s_nop 0
    v_add_f32_dpp v28, v28, v28 quad_perm:[2,3,0,1] row_mask:0xf bank_mask:0xf
    v_add_f32_dpp v30, v30, v30 quad_perm:[2,3,0,1] row_mask:0xf bank_mask:0xf
    v_cvt_pk_bf16_f32 v30, v28, v30
    v_lshlrev_b32 v28, 16, v30
    v_and_b32 v30, 0xffff0000, v30
    v_add_f32_dpp v32, v32, v32 quad_perm:[1,0,3,2] row_mask:0xf bank_mask:0xf
    v_add_f32_dpp v34, v34, v34 quad_perm:[1,0,3,2] row_mask:0xf bank_mask:0xf
    s_nop 0
    v_add_f32_dpp v32, v32, v32 quad_perm:[2,3,0,1] row_mask:0xf bank_mask:0xf
    v_add_f32_dpp v34, v34, v34 quad_perm:[2,3,0,1] row_mask:0xf bank_mask:0xf
    v_cvt_pk_bf16_f32 v34, v32, v34
    v_lshlrev_b32 v32, 16, v34
    v_and_b32 v34, 0xffff0000, v34
    v_add_f32 v32, 1.0, v32
    v_add_f32 v34, 1.0, v34
    v_cvt_pk_bf16_f32 v32, v32, v32
    v_and_b32 v32, 0xffff0000, v32
    v_cvt_pk_bf16_f32 v34, v34, v34
    v_and_b32 v34, 0xffff0000, v34
    v_lshlrev_b32 v2, 3, v2
    v_add_u32 v2, 154368, v2
    ds_write2_b32 v2, v28, v30 offset0:0 offset1:1
    ds_write2_b32 v2, v32, v34 offset0:112 offset1:113
    s_lshl_b32 s3, s64, 2
    s_add_u32 s3, s3, 160896
    v_mov_b32 v3, s3
    v_mov_b32 v5, 1
    ds_write_b32 v3, v5
    s_mov_b32 s65, 0
    v_mov_b32 v2, 160912
lf_27:
    ds_read_b128 v[24:27], v2
    s_waitcnt lgkmcnt(0)
    v_and_b32 v24, v24, v25
    v_and_b32 v26, v26, v27
    v_and_b32 v24, v24, v26
    v_cmp_eq_u32 vcc, 0, v24
    s_cbranch_vccz lfd_28
    s_add_u32 s65, s65, 1
    s_cmp_lt_u32 s65, 400000
    s_cbranch_scc1 lf_27
lfd_28:
    s_mov_b32 s15, 0
    buffer_load_dwordx4 v[160:163], v127, s[20:23], s15 offen
    s_mov_b32 s15, 3584
    buffer_load_dwordx4 v[164:167], v127, s[20:23], s15 offen
    s_mov_b32 s15, 7168
    buffer_load_dwordx4 v[168:171], v127, s[20:23], s15 offen
    s_mov_b32 s15, 10752
    buffer_load_dwordx4 v[172:175], v127, s[20:23], s15 offen
    s_mov_b32 s15, 1792
    buffer_load_dwordx4 v[176:179], v127, s[20:23], s15 offen
    s_mov_b32 s15, 5376
    buffer_load_dwordx4 v[180:183], v127, s[20:23], s15 offen
    s_mov_b32 s15, 8960
    buffer_load_dwordx4 v[184:187], v127, s[20:23], s15 offen
    s_mov_b32 s15, 12544
    buffer_load_dwordx4 v[188:191], v127, s[20:23], s15 offen
    s_mov_b32 s15, 14336
    buffer_load_dwordx4 v[192:195], v127, s[20:23], s15 offen
    s_mov_b32 s15, 17920
    buffer_load_dwordx4 v[196:199], v127, s[20:23], s15 offen
    s_mov_b32 s15, 21504
    buffer_load_dwordx4 v[200:203], v127, s[20:23], s15 offen
    s_mov_b32 s15, 25088
    buffer_load_dwordx4 v[204:207], v127, s[20:23], s15 offen
    s_mov_b32 s15, 16128
    buffer_load_dwordx4 v[208:211], v127, s[20:23], s15 offen
    s_mov_b32 s15, 19712
    buffer_load_dwordx4 v[212:215], v127, s[20:23], s15 offen
    s_mov_b32 s15, 23296
    buffer_load_dwordx4 v[216:219], v127, s[20:23], s15 offen
    s_mov_b32 s15, 26880
    buffer_load_dwordx4 v[220:223], v127, s[20:23], s15 offen
    s_mov_b32 s15, 28672
    buffer_load_dwordx4 v[224:227], v127, s[20:23], s15 offen
    s_mov_b32 s15, 32256
    buffer_load_dwordx4 v[228:231], v127, s[20:23], s15 offen
    s_mov_b32 s15, 35840
    buffer_load_dwordx4 v[232:235], v127, s[20:23], s15 offen
    s_mov_b32 s15, 39424
    buffer_load_dwordx4 v[236:239], v127, s[20:23], s15 offen
    s_mov_b32 s15, 30464
    buffer_load_dwordx4 v[240:243], v127, s[20:23], s15 offen
    s_mov_b32 s15, 34048
    buffer_load_dwordx4 v[244:247], v127, s[20:23], s15 offen
    s_mov_b32 s15, 37632
    buffer_load_dwordx4 v[248:251], v127, s[20:23], s15 offen
    s_mov_b32 s15, 41216
    buffer_load_dwordx4 v[252:255], v127, s[20:23], s15 offen
    s_mov_b32 s15, 43008
    buffer_load_dwordx4 v[92:95], v127, s[20:23], s15 offen
    s_mov_b32 s15, 46592
    buffer_load_dwordx4 v[96:99], v127, s[20:23], s15 offen
    s_mov_b32 s15, 50176
    buffer_load_dwordx4 v[100:103], v127, s[20:23], s15 offen
    s_mov_b32 s15, 53760
    buffer_load_dwordx4 v[104:107], v127, s[20:23], s15 offen
    s_mov_b32 s15, 44800
    buffer_load_dwordx4 v[108:111], v127, s[20:23], s15 offen
    s_mov_b32 s15, 48384
    buffer_load_dwordx4 v[112:115], v127, s[20:23], s15 offen
    s_mov_b32 s15, 51968
    buffer_load_dwordx4 v[116:119], v127, s[20:23], s15 offen
    s_mov_b32 s15, 55552
    buffer_load_dwordx4 v[120:123], v127, s[20:23], s15 offen
L_noc:
    s_mul_i32 s15, s17, 7
    s_lshr_b32 s15, s15, 2
    s_lshl_b32 s15, s15, 3
    v_min_u32 v2, 23, v1
    v_add_u32 v2, s15, v2
    v_min_u32 v2, 223, v2
    v_lshlrev_b32 v2, 7, v2
    v_add_u32 v2, 131072, v2
    s_mov_b32 s65, 0
poll_29:
    global_load_dword v3, v2, s[50:51] sc1
    s_waitcnt vmcnt(0)
    v_cmp_ne_u32 vcc, s7, v3
    s_cbranch_vccz pdone_30
    s_add_u32 s65, s65, 1
    s_cmp_lt_u32 s65, 20000
    s_sleep 2
    s_cbranch_scc1 poll_29
pdone_30:
    s_mov_b32 s31, 0
    s_cmp_lt_u32 s5, 28
    s_cbranch_scc0 L_early
    s_mov_b32 s65, 0
    v_mov_b32 v2, 160976
lf_32:
    ds_read_b128 v[24:27], v2
    s_waitcnt lgkmcnt(0)
    v_and_b32 v24, v24, v25
    v_and_b32 v26, v26, v27
    v_and_b32 v24, v24, v26
    v_cmp_eq_u32 vcc, 0, v24
    s_cbranch_vccz lfd_33
    s_add_u32 s65, s65, 1
    s_cmp_lt_u32 s65, 400000
    s_cbranch_scc1 lf_32
lfd_33:
    v_mov_b32 v2, 161024
    ds_read_b32 v3, v2
    s_waitcnt lgkmcnt(0)
    v_readfirstlane_b32 s3, v3
    s_cmp_eq_u32 s3, 0
    s_cbranch_scc0 L_late
L_early:
    s_sub_u32 s15, s6, 4
    s_lshl_b32 s15, s15, 10
    s_add_u32 m0, s15, 66816
    s_add_u32 s3, s15, 0
    buffer_load_dwordx4 v23, s[56:59], s3 offen sc1 lds
    s_add_u32 m0, s15, 70912
    s_add_u32 s3, s15, 4096
    buffer_load_dwordx4 v23, s[56:59], s3 offen sc1 lds
    s_add_u32 m0, s15, 75008
    s_add_u32 s3, s15, 8192
    buffer_load_dwordx4 v23, s[56:59], s3 offen sc1 lds
    s_add_u32 m0, s15, 79104
    s_add_u32 s3, s15, 12288
    buffer_load_dwordx4 v23, s[56:59], s3 offen sc1 lds
    s_add_u32 m0, s15, 83200
    s_add_u32 s3, s15, 16384
    buffer_load_dwordx4 v23, s[56:59], s3 offen sc1 lds
    s_add_u32 m0, s15, 87296
    s_add_u32 s3, s15, 20480
    buffer_load_dwordx4 v23, s[56:59], s3 offen sc1 lds
    s_add_u32 m0, s15, 91392
    s_add_u32 s3, s15, 24576
    buffer_load_dwordx4 v23, s[56:59], s3 offen sc1 lds
    s_add_u32 m0, s15, 95488
    s_add_u32 s3, s15, 28672
    buffer_load_dwordx4 v23, s[56:59], s3 offen sc1 lds
    s_add_u32 m0, s15, 99584
    s_add_u32 s3, s15, 32768
    buffer_load_dwordx4 v23, s[56:59], s3 offen sc1 lds
    s_add_u32 m0, s15, 103680
    s_add_u32 s3, s15, 36864
    buffer_load_dwordx4 v23, s[56:59], s3 offen sc1 lds
    s_add_u32 m0, s15, 107776
    s_add_u32 s3, s15, 40960
    buffer_load_dwordx4 v23, s[56:59], s3 offen sc1 lds
    s_add_u32 m0, s15, 111872
    s_add_u32 s3, s15, 45056
    buffer_load_dwordx4 v23, s[56:59], s3 offen sc1 lds
    s_add_u32 m0, s15, 115968
    s_add_u32 s3, s15, 49152
    buffer_load_dwordx4 v23, s[56:59], s3 offen sc1 lds
    s_add_u32 m0, s15, 120064
    s_add_u32 s3, s15, 53248
    buffer_load_dwordx4 v23, s[56:59], s3 offen sc1 lds
    s_add_u32 m0, s15, 124160
    s_add_u32 s3, s15, 57344
    buffer_load_dwordx4 v23, s[56:59], s3 offen sc1 lds
    s_add_u32 m0, s15, 128256
    s_add_u32 s3, s15, 61440
    buffer_load_dwordx4 v23, s[56:59], s3 offen sc1 lds
    s_add_u32 m0, s15, 132352
    s_add_u32 s3, s15, 65536
    buffer_load_dwordx4 v23, s[56:59], s3 offen sc1 lds
    s_add_u32 m0, s15, 136448
    s_add_u32 s3, s15, 69632
    buffer_load_dwordx4 v23, s[56:59], s3 offen sc1 lds
    s_add_u32 m0, s15, 140544
    s_add_u32 s3, s15, 73728
    buffer_load_dwordx4 v23, s[56:59], s3 offen sc1 lds
    s_add_u32 m0, s15, 144640
    s_add_u32 s3, s15, 77824
    buffer_load_dwordx4 v23, s[56:59], s3 offen sc1 lds
    s_add_u32 m0, s15, 148736
    s_add_u32 s3, s15, 81920
    buffer_load_dwordx4 v23, s[56:59], s3 offen sc1 lds
    s_add_u32 m0, s15, 152832
    s_add_u32 s3, s15, 86016
    s_cmp_lt_u32 s6, 6
    s_cbranch_scc0 dma_34
    s_cmp_eq_u32 s6, 5
    s_cselect_b32 exec_hi, 0, -1
    buffer_load_dwordx4 v23, s[56:59], s3 offen sc1 lds
dma_34:
    s_mov_b32 exec_hi, -1
    s_mov_b32 s31, 1
L_late:
    s_cmp_lt_u32 s5, 28
    s_cbranch_scc0 L_noc3
    s_setprio 0
    v_lshlrev_b32 v44, 16, v6
    v_and_b32 v52, 0xffff0000, v6
    v_lshlrev_b32 v60, 16, v7
    v_and_b32 v68, 0xffff0000, v7
    v_lshlrev_b32 v45, 16, v8
    v_and_b32 v53, 0xffff0000, v8
    v_lshlrev_b32 v61, 16, v9
    v_and_b32 v69, 0xffff0000, v9
    v_lshlrev_b32 v46, 16, v10
    v_and_b32 v54, 0xffff0000, v10
    v_lshlrev_b32 v62, 16, v11
    v_and_b32 v70, 0xffff0000, v11
    v_lshlrev_b32 v47, 16, v12
    v_and_b32 v55, 0xffff0000, v12
    v_lshlrev_b32 v63, 16, v13
    v_and_b32 v71, 0xffff0000, v13
    v_lshlrev_b32 v48, 16, v14
    v_and_b32 v56, 0xffff0000, v14
    v_lshlrev_b32 v64, 16, v15
    v_and_b32 v72, 0xffff0000, v15
    v_lshlrev_b32 v49, 16, v16
    v_and_b32 v57, 0xffff0000, v16
    v_lshlrev_b32 v65, 16, v17
    v_and_b32 v73, 0xffff0000, v17
    v_lshlrev_b32 v50, 16, v18
    v_and_b32 v58, 0xffff0000, v18
    v_lshlrev_b32 v66, 16, v19
    v_and_b32 v74, 0xffff0000, v19
    v_lshlrev_b32 v51, 16, v20
    v_and_b32 v59, 0xffff0000, v20
    v_lshlrev_b32 v67, 16, v21
    v_and_b32 v75, 0xffff0000, v21
    v_lshrrev_b32 v2, 4, v0
    v_cmp_gt_u32 s[8:9], 14, v2
    v_min_u32 v2, 13, v2
    v_lshlrev_b32 v2, 5, v2
    v_add_u32 v2, 154368, v2
    s_mov_b32 s65, 0
    v_mov_b32 v3, 160896
lf_35:
    ds_read_b128 v[28:31], v3
    s_waitcnt lgkmcnt(0)
    v_and_b32 v28, v28, v29
    v_and_b32 v30, v30, v31
    v_and_b32 v28, v28, v30
    v_cmp_eq_u32 vcc, 0, v28
    s_cbranch_vccz lfd_36
    s_add_u32 s65, s65, 1
    s_cmp_lt_u32 s65, 400000
    s_cbranch_scc1 lf_35
lfd_36:
    ds_read_b128 v[28:31], v2 offset:0
    ds_read_b128 v[36:39], v2 offset:448
    ds_read_b128 v[32:35], v2 offset:16
    ds_read_b128 v[40:43], v2 offset:464
    s_waitcnt lgkmcnt(0)
    v_mul_f32 v76, v36, v44
    v_mul_f32 v80, v28, v44
    v_mul_f32 v77, v36, v52
    v_mul_f32 v81, v28, v52
    v_mul_f32 v78, v36, v60
    v_mul_f32 v82, v28, v60
    v_mul_f32 v79, v36, v68
    v_mul_f32 v83, v28, v68
    v_fmac_f32 v76, v37, v45
    v_fmac_f32 v80, v29, v45
    v_fmac_f32 v77, v37, v53
    v_fmac_f32 v81, v29, v53
    v_fmac_f32 v78, v37, v61
    v_fmac_f32 v82, v29, v61
    v_fmac_f32 v79, v37, v69
    v_fmac_f32 v83, v29, v69
    v_fmac_f32 v76, v38, v46
    v_fmac_f32 v80, v30, v46
    v_fmac_f32 v77, v38, v54
    v_fmac_f32 v81, v30, v54
    v_fmac_f32 v78, v38, v62
    v_fmac_f32 v82, v30, v62
    v_fmac_f32 v79, v38, v70
    v_fmac_f32 v83, v30, v70
    v_fmac_f32 v76, v39, v47
    v_fmac_f32 v80, v31, v47
    v_fmac_f32 v77, v39, v55
    v_fmac_f32 v81, v31, v55
    v_fmac_f32 v78, v39, v63
    v_fmac_f32 v82, v31, v63
    v_fmac_f32 v79, v39, v71
    v_fmac_f32 v83, v31, v71
    v_fmac_f32 v76, v40, v48
    v_fmac_f32 v80, v32, v48
    v_fmac_f32 v77, v40, v56
    v_fmac_f32 v81, v32, v56
    v_fmac_f32 v78, v40, v64
    v_fmac_f32 v82, v32, v64
    v_fmac_f32 v79, v40, v72
    v_fmac_f32 v83, v32, v72
    v_fmac_f32 v76, v41, v49
    v_fmac_f32 v80, v33, v49
    v_fmac_f32 v77, v41, v57
    v_fmac_f32 v81, v33, v57
    v_fmac_f32 v78, v41, v65
    v_fmac_f32 v82, v33, v65
    v_fmac_f32 v79, v41, v73
    v_fmac_f32 v83, v33, v73
    v_fmac_f32 v76, v42, v50
    v_fmac_f32 v80, v34, v50
    v_fmac_f32 v77, v42, v58
    v_fmac_f32 v81, v34, v58
    v_fmac_f32 v78, v42, v66
    v_fmac_f32 v82, v34, v66
    v_fmac_f32 v79, v42, v74
    v_fmac_f32 v83, v34, v74
    v_fmac_f32 v76, v43, v51
    v_fmac_f32 v80, v35, v51
    v_fmac_f32 v77, v43, v59
    v_fmac_f32 v81, v35, v59
    v_fmac_f32 v78, v43, v67
    v_fmac_f32 v82, v35, v67
    v_fmac_f32 v79, v43, v75
    v_fmac_f32 v83, v35, v75
    v_cndmask_b32 v76, 0, v76, s[8:9]
    v_cndmask_b32 v77, 0, v77, s[8:9]
    v_cndmask_b32 v78, 0, v78, s[8:9]
    v_cndmask_b32 v79, 0, v79, s[8:9]
    v_cndmask_b32 v80, 0, v80, s[8:9]
    v_cndmask_b32 v81, 0, v81, s[8:9]
    v_cndmask_b32 v82, 0, v82, s[8:9]
    v_cndmask_b32 v83, 0, v83, s[8:9]
    v_mov_b32 v44, v76
    v_mov_b32 v45, v77
    v_mov_b32 v46, v78
    v_mov_b32 v47, v79
    v_mov_b32 v48, v80
    v_mov_b32 v49, v81
    v_mov_b32 v50, v82
    v_mov_b32 v51, v83
    v_permlane16_swap_b32 v76, v44
    v_permlane16_swap_b32 v77, v45
    v_permlane16_swap_b32 v78, v46
    v_permlane16_swap_b32 v79, v47
    v_permlane16_swap_b32 v80, v48
    v_permlane16_swap_b32 v81, v49
    v_permlane16_swap_b32 v82, v50
    v_permlane16_swap_b32 v83, v51
    v_add_f32 v76, v76, v44
    v_add_f32 v77, v77, v45
    v_add_f32 v78, v78, v46
    v_add_f32 v79, v79, v47
    v_add_f32 v80, v80, v48
    v_add_f32 v81, v81, v49
    v_add_f32 v82, v82, v50
    v_add_f32 v83, v83, v51
    v_mov_b32 v44, v76
    v_mov_b32 v45, v77
    v_mov_b32 v46, v78
    v_mov_b32 v47, v79
    v_mov_b32 v48, v80
    v_mov_b32 v49, v81
    v_mov_b32 v50, v82
    v_mov_b32 v51, v83
    v_permlane32_swap_b32 v76, v44
    v_permlane32_swap_b32 v77, v45
    v_permlane32_swap_b32 v78, v46
    v_permlane32_swap_b32 v79, v47
    v_permlane32_swap_b32 v80, v48
    v_permlane32_swap_b32 v81, v49
    v_permlane32_swap_b32 v82, v50
    v_permlane32_swap_b32 v83, v51
    v_add_f32 v76, v76, v44
    v_add_f32 v77, v77, v45
    v_add_f32 v78, v78, v46
    v_add_f32 v79, v79, v47
    v_add_f32 v80, v80, v48
    v_add_f32 v81, v81, v49
    v_add_f32 v82, v82, v50
    v_add_f32 v83, v83, v51
    s_sub_u32 s15, s6, 4
    s_lshl_b32 s3, s15, 9
    s_add_u32 s3, s3, 161536
    v_lshl_add_u32 v3, v1, 5, s3
    s_mov_b64 exec, 0xffff
    ds_write_b128 v3, v[76:79]
    ds_write_b128 v3, v[80:83] offset:16
    s_mov_b64 exec, -1
    s_lshl_b32 s3, s15, 2
    s_add_u32 s3, s3, 160784
    v_mov_b32 v3, s3
    v_mov_b32 v5, 1
    ds_write_b32 v3, v5
    s_cmp_lt_u32 s6, 6
    s_cbranch_scc0 L_noc3
    s_mov_b32 s65, 0
    v_mov_b32 v3, 160784
lf_37:
    ds_read_b128 v[44:47], v3
    s_waitcnt lgkmcnt(0)
    v_and_b32 v44, v44, v45
    v_and_b32 v46, v46, v47
    v_and_b32 v44, v44, v46
    v_cmp_eq_u32 vcc, 0, v44
    s_cbranch_vccz lfd_38
    s_add_u32 s65, s65, 1
    s_cmp_lt_u32 s65, 400000
    s_cbranch_scc1 lf_37
lfd_38:
    s_sub_u32 s15, s6, 4
    v_lshrrev_b32 v3, 5, v1
    v_lshl_add_u32 v3, s15, 1, v3
    v_and_b32 v4, 3, v1
    v_lshl_add_u32 v5, v3, 2, v4
    v_lshlrev_b32 v5, 5, v5
    v_and_b32 v4, 28, v1
    v_add3_u32 v5, v5, v4, 0
    v_add_u32 v5, 161536, v5
    ds_read_b32 v44, v5 offset:0
    ds_read_b32 v46, v5 offset:512
    ds_read_b32 v48, v5 offset:1024
    ds_read_b32 v50, v5 offset:1536
    s_and_b32 s3, s10, 3
    s_mul_i32 s3, s3, 57344
    s_lshr_b32 s15, s10, 3
    s_lshl_b32 s15, s15, 11
    s_add_u32 s3, s3, s15
    s_bfe_u32 s15, s10, 0x10002
    s_lshl_b32 s15, s15, 8
    s_add_u32 s3, s3, s15
    s_add_u32 s3, s3, 393216
    v_lshlrev_b32 v3, 9, v3
    v_and_b32 v4, 31, v1
    v_lshlrev_b32 v4, 3, v4
    v_add3_u32 v3, v3, v4, s3
    v_mov_b32 v45, s7
    s_waitcnt lgkmcnt(0)
    v_add_f32 v44, v44, v46
    v_add_f32 v48, v48, v50
    v_add_f32 v44, v44, v48
    global_store_dwordx2 v3, v[44:45], s[50:51] sc1
L_noc3:
    s_setprio 2
    s_barrier
    s_cmp_eq_u32 s31, 1
    s_cbranch_scc1 L_done02
    s_sub_u32 s15, s6, 4
    s_lshl_b32 s15, s15, 10
    s_add_u32 m0, s15, 66816
    s_add_u32 s3, s15, 0
    buffer_load_dwordx4 v23, s[56:59], s3 offen sc1 lds
    s_add_u32 m0, s15, 70912
    s_add_u32 s3, s15, 4096
    buffer_load_dwordx4 v23, s[56:59], s3 offen sc1 lds
    s_add_u32 m0, s15, 75008
    s_add_u32 s3, s15, 8192
    buffer_load_dwordx4 v23, s[56:59], s3 offen sc1 lds
    s_add_u32 m0, s15, 79104
    s_add_u32 s3, s15, 12288
    buffer_load_dwordx4 v23, s[56:59], s3 offen sc1 lds
    s_add_u32 m0, s15, 83200
    s_add_u32 s3, s15, 16384
    buffer_load_dwordx4 v23, s[56:59], s3 offen sc1 lds
    s_add_u32 m0, s15, 87296
    s_add_u32 s3, s15, 20480
    buffer_load_dwordx4 v23, s[56:59], s3 offen sc1 lds
    s_add_u32 m0, s15, 91392
    s_add_u32 s3, s15, 24576
    buffer_load_dwordx4 v23, s[56:59], s3 offen sc1 lds
    s_add_u32 m0, s15, 95488
    s_add_u32 s3, s15, 28672
    buffer_load_dwordx4 v23, s[56:59], s3 offen sc1 lds
    s_add_u32 m0, s15, 99584
    s_add_u32 s3, s15, 32768
    buffer_load_dwordx4 v23, s[56:59], s3 offen sc1 lds
    s_add_u32 m0, s15, 103680
    s_add_u32 s3, s15, 36864
    buffer_load_dwordx4 v23, s[56:59], s3 offen sc1 lds
    s_add_u32 m0, s15, 107776
    s_add_u32 s3, s15, 40960
    buffer_load_dwordx4 v23, s[56:59], s3 offen sc1 lds
    s_add_u32 m0, s15, 111872
    s_add_u32 s3, s15, 45056
    buffer_load_dwordx4 v23, s[56:59], s3 offen sc1 lds
    s_add_u32 m0, s15, 115968
    s_add_u32 s3, s15, 49152
    buffer_load_dwordx4 v23, s[56:59], s3 offen sc1 lds
    s_add_u32 m0, s15, 120064
    s_add_u32 s3, s15, 53248
    buffer_load_dwordx4 v23, s[56:59], s3 offen sc1 lds
    s_add_u32 m0, s15, 124160
    s_add_u32 s3, s15, 57344
    buffer_load_dwordx4 v23, s[56:59], s3 offen sc1 lds
    s_add_u32 m0, s15, 128256
    s_add_u32 s3, s15, 61440
    buffer_load_dwordx4 v23, s[56:59], s3 offen sc1 lds
    s_add_u32 m0, s15, 132352
    s_add_u32 s3, s15, 65536
    buffer_load_dwordx4 v23, s[56:59], s3 offen sc1 lds
    s_add_u32 m0, s15, 136448
    s_add_u32 s3, s15, 69632
    buffer_load_dwordx4 v23, s[56:59], s3 offen sc1 lds
    s_add_u32 m0, s15, 140544
    s_add_u32 s3, s15, 73728
    buffer_load_dwordx4 v23, s[56:59], s3 offen sc1 lds
    s_add_u32 m0, s15, 144640
    s_add_u32 s3, s15, 77824
    buffer_load_dwordx4 v23, s[56:59], s3 offen sc1 lds
    s_add_u32 m0, s15, 148736
    s_add_u32 s3, s15, 81920
    buffer_load_dwordx4 v23, s[56:59], s3 offen sc1 lds
    s_add_u32 m0, s15, 152832
    s_add_u32 s3, s15, 86016
    s_cmp_lt_u32 s6, 6
    s_cbranch_scc0 dma_39
    s_cmp_eq_u32 s6, 5
    s_cselect_b32 exec_hi, 0, -1
    buffer_load_dwordx4 v23, s[56:59], s3 offen sc1 lds
dma_39:
    s_mov_b32 exec_hi, -1
L_done02:
    s_sub_u32 s15, s6, 4
    s_lshl_b32 s15, s15, 10
    s_add_u32 m0, s15, 0
    s_add_u32 s3, s15, 87552
    buffer_load_dwordx4 v23, s[56:59], s3 offen sc1 lds
    s_add_u32 m0, s15, 4096
    s_add_u32 s3, s15, 91648
    buffer_load_dwordx4 v23, s[56:59], s3 offen sc1 lds
    s_add_u32 m0, s15, 8192
    s_add_u32 s3, s15, 95744
    buffer_load_dwordx4 v23, s[56:59], s3 offen sc1 lds
    s_add_u32 m0, s15, 12288
    s_add_u32 s3, s15, 99840
    buffer_load_dwordx4 v23, s[56:59], s3 offen sc1 lds
    s_add_u32 m0, s15, 16384
    s_add_u32 s3, s15, 103936
    buffer_load_dwordx4 v23, s[56:59], s3 offen sc1 lds
    s_add_u32 m0, s15, 20480
    s_add_u32 s3, s15, 108032
    buffer_load_dwordx4 v23, s[56:59], s3 offen sc1 lds
    s_add_u32 m0, s15, 24576
    s_add_u32 s3, s15, 112128
    buffer_load_dwordx4 v23, s[56:59], s3 offen sc1 lds
    s_add_u32 m0, s15, 28672
    s_add_u32 s3, s15, 116224
    buffer_load_dwordx4 v23, s[56:59], s3 offen sc1 lds
    s_add_u32 m0, s15, 32768
    s_add_u32 s3, s15, 120320
    buffer_load_dwordx4 v23, s[56:59], s3 offen sc1 lds
    s_add_u32 m0, s15, 36864
    s_add_u32 s3, s15, 124416
    buffer_load_dwordx4 v23, s[56:59], s3 offen sc1 lds
    s_add_u32 m0, s15, 40960
    s_add_u32 s3, s15, 128512
    buffer_load_dwordx4 v23, s[56:59], s3 offen sc1 lds
    s_add_u32 m0, s15, 45056
    s_add_u32 s3, s15, 132608
    buffer_load_dwordx4 v23, s[56:59], s3 offen sc1 lds
    s_add_u32 m0, s15, 49152
    s_add_u32 s3, s15, 136704
    buffer_load_dwordx4 v23, s[56:59], s3 offen sc1 lds
    s_add_u32 m0, s15, 53248
    s_add_u32 s3, s15, 140800
    buffer_load_dwordx4 v23, s[56:59], s3 offen sc1 lds
    s_add_u32 m0, s15, 57344
    s_add_u32 s3, s15, 144896
    s_cmp_lt_u32 s6, 5
    s_cbranch_scc0 dma_40
    buffer_load_dwordx4 v23, s[56:59], s3 offen sc1 lds
dma_40:
    s_mov_b32 exec_hi, -1
    v_min_u32 v4, 223, v0
    v_lshlrev_b32 v4, 13, v4
    s_and_b32 s3, s5, 3
    s_lshl_b32 s3, s3, 7
    s_lshl_b32 s15, s16, 9
    s_add_u32 s62, s15, s3
    v_lshrrev_b32 v2, 3, v1
    v_lshlrev_b32 v2, 13, v2
    v_and_b32 v3, 7, v1
    v_lshl_add_u32 v2, v3, 2, v2
    s_sub_u32 s15, s6, 4
    s_mul_i32 s15, s15, 458752
    s_lshl_b32 s3, s16, 9
    s_add_u32 s15, s15, s3
    s_lshl_b32 s3, s17, 5
    s_add_u32 s15, s15, s3
    v_add_u32 v2, s15, v2
    v_min_u32 v4, 55, v1
    s_sub_u32 s15, s6, 4
    s_mul_i32 s15, s15, 56
    v_add_u32 v4, s15, v4
    s_lshr_b32 s3, s16, 2
    s_mul_i32 s3, s3, 224
    v_add_u32 v5, s3, v4
    v_lshlrev_b32 v5, 7, v5
    v_add_u32 v5, 786432, v5
    v_lshlrev_b32 v4, 13, v4
    s_and_b32 s3, s5, 3
    s_lshl_b32 s3, s3, 7
    s_lshl_b32 s15, s16, 9
    s_add_u32 s62, s15, s3
    s_mov_b64 s[8:9], 0
    s_mov_b32 s65, 0
poll_41:
    global_load_dword v3, v5, s[50:51] sc1
    s_waitcnt vmcnt(0)
    v_cmp_ne_u32 vcc, s7, v3
    s_cbranch_vccz pdone_42
    s_add_u32 s65, s65, 1
    s_cmp_lt_u32 s65, 20000
    s_sleep 1
    s_cbranch_scc1 poll_41
pdone_42:
    s_mov_b32 s15, 0
    buffer_load_dword v28, v2, s[36:39], s15 offen sc1
    s_mov_b32 s15, 65536
    buffer_load_dword v29, v2, s[36:39], s15 offen sc1
    s_mov_b32 s15, 131072
    buffer_load_dword v30, v2, s[36:39], s15 offen sc1
    s_mov_b32 s15, 196608
    buffer_load_dword v31, v2, s[36:39], s15 offen sc1
    s_mov_b32 s15, 262144
    buffer_load_dword v32, v2, s[36:39], s15 offen sc1
    s_mov_b32 s15, 327680
    buffer_load_dword v33, v2, s[36:39], s15 offen sc1
    s_mov_b32 s15, 393216
    buffer_load_dword v34, v2, s[36:39], s15 offen sc1
    s_barrier
    s_waitcnt vmcnt(0)
    v_mov_b32 v36, 0
    v_mov_b32 v37, 0
    v_lshlrev_b32 v2, 16, v28
    v_and_b32 v3, 0xffff0000, v28
    v_add_f32 v36, v36, v2
    v_fmac_f32 v37, v2, v2
    v_add_f32 v36, v36, v3
    v_fmac_f32 v37, v3, v3
    v_lshlrev_b32 v2, 16, v29
    v_and_b32 v3, 0xffff0000, v29
    v_add_f32 v36, v36, v2
    v_fmac_f32 v37, v2, v2
    v_add_f32 v36, v36, v3
    v_fmac_f32 v37, v3, v3
    v_lshlrev_b32 v2, 16, v30
    v_and_b32 v3, 0xffff0000, v30
    v_add_f32 v36, v36, v2
    v_fmac_f32 v37, v2, v2
    v_add_f32 v36, v36, v3
    v_fmac_f32 v37, v3, v3
    v_lshlrev_b32 v2, 16, v31
    v_and_b32 v3, 0xffff0000, v31
    v_add_f32 v36, v36, v2
    v_fmac_f32 v37, v2, v2
    v_add_f32 v36, v36, v3
    v_fmac_f32 v37, v3, v3
    v_lshlrev_b32 v2, 16, v32
    v_and_b32 v3, 0xffff0000, v32
    v_add_f32 v36, v36, v2
    v_fmac_f32 v37, v2, v2
    v_add_f32 v36, v36, v3
    v_fmac_f32 v37, v3, v3
    v_lshlrev_b32 v2, 16, v33
    v_and_b32 v3, 0xffff0000, v33
    v_add_f32 v36, v36, v2
    v_fmac_f32 v37, v2, v2
    v_add_f32 v36, v36, v3
    v_fmac_f32 v37, v3, v3
    v_lshlrev_b32 v2, 16, v34
    v_and_b32 v3, 0xffff0000, v34
    v_add_f32 v36, v36, v2
    v_fmac_f32 v37, v2, v2
    v_add_f32 v36, v36, v3
    v_fmac_f32 v37, v3, v3
    s_nop 0
    v_add_f32_dpp v36, v36, v36 row_ror:8 row_mask:0xf bank_mask:0xf
    v_add_f32_dpp v37, v37, v37 row_ror:8 row_mask:0xf bank_mask:0xf
    v_mov_b32 v38, v36
    v_mov_b32 v39, v37
    s_nop 0
    v_permlane16_swap_b32 v36, v38
    v_permlane16_swap_b32 v37, v39
    v_add_f32 v36, v36, v38
    v_add_f32 v37, v37, v39
    v_mov_b32 v38, v36
    v_mov_b32 v39, v37
    s_nop 0
    v_permlane32_swap_b32 v36, v38
    v_permlane32_swap_b32 v37, v39
    v_add_f32 v36, v36, v38
    v_add_f32 v37, v37, v39
    s_sub_u32 s15, s6, 4
    s_lshl_b32 s3, s15, 6
    s_add_u32 s3, s3, 161280
    v_lshl_add_u32 v3, v1, 3, s3
    s_mov_b64 exec, 0xff
    ds_write_b64 v3, v[36:37]
    s_mov_b64 exec, -1
    s_lshl_b32 s3, s15, 2
    s_add_u32 s3, s3, 160800
    v_mov_b32 v3, s3
    v_mov_b32 v5, 1
    ds_write_b32 v3, v5
    s_cmp_eq_u32 s6, 4
    s_cbranch_scc0 L_nos2
    s_mov_b32 s65, 0
    v_mov_b32 v3, 160800
lf_44:
    ds_read_b128 v[28:31], v3
    s_waitcnt lgkmcnt(0)
    v_and_b32 v28, v28, v29
    v_and_b32 v30, v30, v31
    v_and_b32 v28, v28, v30
    v_cmp_eq_u32 vcc, 0, v28
    s_cbranch_vccz lfd_45
    s_add_u32 s65, s65, 1
    s_cmp_lt_u32 s65, 400000
    s_cbranch_scc1 lf_44
lfd_45:
    v_and_b32 v3, 7, v1
    v_lshlrev_b32 v4, 3, v3
    v_add_u32 v4, 161280, v4
    ds_read_b64 v[28:29], v4 offset:0
    ds_read_b64 v[30:31], v4 offset:64
    ds_read_b64 v[32:33], v4 offset:128
    ds_read_b64 v[34:35], v4 offset:192
    s_lshl_b32 s15, s16, 4
    s_add_u32 s15, s15, s17
    s_lshl_b32 s15, s15, 7
    s_add_u32 s15, s15, 32768
    v_lshl_add_u32 v3, v3, 4, s15
    s_waitcnt lgkmcnt(0)
    v_add_f32 v28, v28, v30
    v_add_f32 v32, v32, v34
    v_add_f32 v28, v28, v32
    v_add_f32 v29, v29, v31
    v_add_f32 v33, v33, v35
    v_add_f32 v29, v29, v33
    v_mul_f32 v28, 0x3b124925, v28
    v_mul_f32 v29, 0x3b124925, v29
    v_fma_f32 v29, -v28, v28, v29
    v_max_f32 v29, 0, v29
    v_cvt_pk_bf16_f32 v29, v29, v29
    v_and_b32 v29, 0xffff0000, v29
    v_add_f32 v29, 0x3727c5ac, v29
    v_cvt_pk_bf16_f32 v29, v29, v29
    v_and_b32 v29, 0xffff0000, v29
    v_sqrt_f32 v29, v29
    s_nop 0
    v_cvt_pk_bf16_f32 v29, v29, v29
    v_and_b32 v29, 0xffff0000, v29
    v_rcp_f32 v38, v29
    v_mov_b32 v37, s7
    v_mov_b32 v39, s7
    v_mul_f32 v36, v28, v38
    v_sub_f32 v36, 0, v36
    s_mov_b64 exec, 0xff
    global_store_dwordx4 v3, v[36:39], s[50:51] sc1
    s_mov_b64 exec, -1
L_nos2:
    v_min_u32 v2, 223, v0
    s_mul_i32 s15, s17, 3584
    s_add_u32 s15, s15, 393216
    v_lshl_add_u32 v3, v2, 4, s15
    v_bfe_u32 v4, v0, 2, 5
    v_and_b32 v5, 3, v0
    v_mul_u32_u24 v5, 21504, v5
    v_lshl_add_u32 v5, v4, 4, v5
    s_min_u32 s15, s19, 6
    s_lshl_b32 s15, s15, 9
    s_add_u32 s15, s15, 181760
    v_add_u32 v5, s15, v5
    v_add_u32 v52, 57344, v3
    v_add_u32 v53, 114688, v3
    v_add_u32 v54, 172032, v3
    s_mov_b32 s65, 0
poll_46:
    global_load_dwordx4 v[28:31], v3, s[50:51] sc1
    global_load_dwordx4 v[32:35], v5, s[50:51] sc1
    global_load_dwordx4 v[40:43], v52, s[50:51] sc1
    global_load_dwordx4 v[44:47], v53, s[50:51] sc1
    global_load_dwordx4 v[48:51], v54, s[50:51] sc1
    s_waitcnt vmcnt(0)
    v_xor_b32 v29, s7, v29
    v_xor_b32 v31, s7, v31
    v_xor_b32 v33, s7, v33
    v_xor_b32 v35, s7, v35
    v_xor_b32 v41, s7, v41
    v_xor_b32 v43, s7, v43
    v_xor_b32 v45, s7, v45
    v_xor_b32 v47, s7, v47
    v_xor_b32 v49, s7, v49
    v_xor_b32 v51, s7, v51
    v_or3_b32 v29, v29, v31, v33
    v_or3_b32 v29, v29, v35, v41
    v_or3_b32 v29, v29, v43, v45
    v_or3_b32 v29, v29, v47, v49
    v_or_b32 v29, v29, v51
    v_cmp_ne_u32 vcc, 0, v29
    s_cbranch_vccz pdone_47
    s_add_u32 s65, s65, 1
    s_cmp_lt_u32 s65, 20000
    s_sleep 2
    s_cbranch_scc1 poll_46
pdone_47:
    v_add_f32 v28, v28, v40
    v_add_f32 v44, v44, v48
    v_add_f32 v28, v28, v44
    v_add_f32 v30, v30, v42
    v_add_f32 v46, v46, v50
    v_add_f32 v30, v30, v46
    v_lshlrev_b32 v2, 3, v2
    v_add_u32 v2, 157952, v2
    ds_write2_b32 v2, v28, v30 offset0:0 offset1:1
    v_add_f32_dpp v32, v32, v32 quad_perm:[1,0,3,2] row_mask:0xf bank_mask:0xf
    v_add_f32_dpp v34, v34, v34 quad_perm:[1,0,3,2] row_mask:0xf bank_mask:0xf
    s_nop 0
    v_add_f32_dpp v32, v32, v32 quad_perm:[2,3,0,1] row_mask:0xf bank_mask:0xf
    v_add_f32_dpp v34, v34, v34 quad_perm:[2,3,0,1] row_mask:0xf bank_mask:0xf
    v_cvt_pk_bf16_f32 v34, v32, v34
    v_lshlrev_b32 v32, 16, v34
    v_and_b32 v34, 0xffff0000, v34
    v_lshlrev_b32 v4, 3, v4
    v_add_u32 v4, 159744, v4
    ds_write2_b32 v4, v32, v34 offset0:0 offset1:1
    s_cmp_lt_u32 s5, 28
    s_cbranch_scc0 L_noperm
    s_setprio 0
    s_mov_b32 s8, 0x05040100
    s_mov_b32 s9, 0x07060302
    v_perm_b32 v128, v164, v160, s8
    v_perm_b32 v24, v164, v160, s8
    v_perm_b32 v144, v166, v162, s8
    v_perm_b32 v129, v172, v168, s8
    v_perm_b32 v25, v172, v168, s8
    v_perm_b32 v145, v174, v170, s8
    v_perm_b32 v130, v180, v176, s8
    v_perm_b32 v26, v180, v176, s8
    v_perm_b32 v146, v182, v178, s8
    v_perm_b32 v131, v188, v184, s8
    v_perm_b32 v27, v188, v184, s8
    v_perm_b32 v147, v190, v186, s8
    v_mov_b32_dpp v128, v144 row_ror:8 row_mask:0xf bank_mask:0xc
    v_mov_b32_dpp v129, v145 row_ror:8 row_mask:0xf bank_mask:0xc
    v_mov_b32_dpp v130, v146 row_ror:8 row_mask:0xf bank_mask:0xc
    v_mov_b32_dpp v131, v147 row_ror:8 row_mask:0xf bank_mask:0xc
    v_mov_b32_dpp v144, v24 row_ror:8 row_mask:0xf bank_mask:0x3
    v_mov_b32_dpp v145, v25 row_ror:8 row_mask:0xf bank_mask:0x3
    v_mov_b32_dpp v146, v26 row_ror:8 row_mask:0xf bank_mask:0x3
    v_mov_b32_dpp v147, v27 row_ror:8 row_mask:0xf bank_mask:0x3
    v_perm_b32 v132, v164, v160, s9
    v_perm_b32 v24, v164, v160, s9
    v_perm_b32 v148, v166, v162, s9
    v_perm_b32 v133, v172, v168, s9
    v_perm_b32 v25, v172, v168, s9
    v_perm_b32 v149, v174, v170, s9
    v_perm_b32 v134, v180, v176, s9
    v_perm_b32 v26, v180, v176, s9
    v_perm_b32 v150, v182, v178, s9
    v_perm_b32 v135, v188, v184, s9
    v_perm_b32 v27, v188, v184, s9
    v_perm_b32 v151, v190, v186, s9
    v_mov_b32_dpp v132, v148 row_ror:8 row_mask:0xf bank_mask:0xc
    v_mov_b32_dpp v133, v149 row_ror:8 row_mask:0xf bank_mask:0xc
    v_mov_b32_dpp v134, v150 row_ror:8 row_mask:0xf bank_mask:0xc
    v_mov_b32_dpp v135, v151 row_ror:8 row_mask:0xf bank_mask:0xc
    v_mov_b32_dpp v148, v24 row_ror:8 row_mask:0xf bank_mask:0x3
    v_mov_b32_dpp v149, v25 row_ror:8 row_mask:0xf bank_mask:0x3
    v_mov_b32_dpp v150, v26 row_ror:8 row_mask:0xf bank_mask:0x3
    v_mov_b32_dpp v151, v27 row_ror:8 row_mask:0xf bank_mask:0x3
    v_perm_b32 v136, v165, v161, s8
    v_perm_b32 v24, v165, v161, s8
    v_perm_b32 v152, v167, v163, s8
    v_perm_b32 v137, v173, v169, s8
    v_perm_b32 v25, v173, v169, s8
    v_perm_b32 v153, v175, v171, s8
    v_perm_b32 v138, v181, v177, s8
    v_perm_b32 v26, v181, v177, s8
    v_perm_b32 v154, v183, v179, s8
    v_perm_b32 v139, v189, v185, s8
    v_perm_b32 v27, v189, v185, s8
    v_perm_b32 v155, v191, v187, s8
    v_mov_b32_dpp v136, v152 row_ror:8 row_mask:0xf bank_mask:0xc
    v_mov_b32_dpp v137, v153 row_ror:8 row_mask:0xf bank_mask:0xc
    v_mov_b32_dpp v138, v154 row_ror:8 row_mask:0xf bank_mask:0xc
    v_mov_b32_dpp v139, v155 row_ror:8 row_mask:0xf bank_mask:0xc
    v_mov_b32_dpp v152, v24 row_ror:8 row_mask:0xf bank_mask:0x3
    v_mov_b32_dpp v153, v25 row_ror:8 row_mask:0xf bank_mask:0x3
    v_mov_b32_dpp v154, v26 row_ror:8 row_mask:0xf bank_mask:0x3
    v_mov_b32_dpp v155, v27 row_ror:8 row_mask:0xf bank_mask:0x3
    v_perm_b32 v140, v165, v161, s9
    v_perm_b32 v24, v165, v161, s9
    v_perm_b32 v156, v167, v163, s9
    v_perm_b32 v141, v173, v169, s9
    v_perm_b32 v25, v173, v169, s9
    v_perm_b32 v157, v175, v171, s9
    v_perm_b32 v142, v181, v177, s9
    v_perm_b32 v26, v181, v177, s9
    v_perm_b32 v158, v183, v179, s9
    v_perm_b32 v143, v189, v185, s9
    v_perm_b32 v27, v189, v185, s9
    v_perm_b32 v159, v191, v187, s9
    v_mov_b32_dpp v140, v156 row_ror:8 row_mask:0xf bank_mask:0xc
    v_mov_b32_dpp v141, v157 row_ror:8 row_mask:0xf bank_mask:0xc
    v_mov_b32_dpp v142, v158 row_ror:8 row_mask:0xf bank_mask:0xc
    v_mov_b32_dpp v143, v159 row_ror:8 row_mask:0xf bank_mask:0xc
    v_mov_b32_dpp v156, v24 row_ror:8 row_mask:0xf bank_mask:0x3
    v_mov_b32_dpp v157, v25 row_ror:8 row_mask:0xf bank_mask:0x3
    v_mov_b32_dpp v158, v26 row_ror:8 row_mask:0xf bank_mask:0x3
    v_mov_b32_dpp v159, v27 row_ror:8 row_mask:0xf bank_mask:0x3
    v_perm_b32 v160, v196, v192, s8
    v_perm_b32 v24, v196, v192, s8
    v_perm_b32 v176, v198, v194, s8
    v_perm_b32 v161, v204, v200, s8
    v_perm_b32 v25, v204, v200, s8
    v_perm_b32 v177, v206, v202, s8
    v_perm_b32 v162, v212, v208, s8
    v_perm_b32 v26, v212, v208, s8
    v_perm_b32 v178, v214, v210, s8
    v_perm_b32 v163, v220, v216, s8
    v_perm_b32 v27, v220, v216, s8
    v_perm_b32 v179, v222, v218, s8
    v_mov_b32_dpp v160, v176 row_ror:8 row_mask:0xf bank_mask:0xc
    v_mov_b32_dpp v161, v177 row_ror:8 row_mask:0xf bank_mask:0xc
    v_mov_b32_dpp v162, v178 row_ror:8 row_mask:0xf bank_mask:0xc
    v_mov_b32_dpp v163, v179 row_ror:8 row_mask:0xf bank_mask:0xc
    v_mov_b32_dpp v176, v24 row_ror:8 row_mask:0xf bank_mask:0x3
    v_mov_b32_dpp v177, v25 row_ror:8 row_mask:0xf bank_mask:0x3
    v_mov_b32_dpp v178, v26 row_ror:8 row_mask:0xf bank_mask:0x3
    v_mov_b32_dpp v179, v27 row_ror:8 row_mask:0xf bank_mask:0x3
    v_perm_b32 v164, v196, v192, s9
    v_perm_b32 v24, v196, v192, s9
    v_perm_b32 v180, v198, v194, s9
    v_perm_b32 v165, v204, v200, s9
    v_perm_b32 v25, v204, v200, s9
    v_perm_b32 v181, v206, v202, s9
    v_perm_b32 v166, v212, v208, s9
    v_perm_b32 v26, v212, v208, s9
    v_perm_b32 v182, v214, v210, s9
    v_perm_b32 v167, v220, v216, s9
    v_perm_b32 v27, v220, v216, s9
    v_perm_b32 v183, v222, v218, s9
    v_mov_b32_dpp v164, v180 row_ror:8 row_mask:0xf bank_mask:0xc
    v_mov_b32_dpp v165, v181 row_ror:8 row_mask:0xf bank_mask:0xc
    v_mov_b32_dpp v166, v182 row_ror:8 row_mask:0xf bank_mask:0xc
    v_mov_b32_dpp v167, v183 row_ror:8 row_mask:0xf bank_mask:0xc
    v_mov_b32_dpp v180, v24 row_ror:8 row_mask:0xf bank_mask:0x3
    v_mov_b32_dpp v181, v25 row_ror:8 row_mask:0xf bank_mask:0x3
    v_mov_b32_dpp v182, v26 row_ror:8 row_mask:0xf bank_mask:0x3
    v_mov_b32_dpp v183, v27 row_ror:8 row_mask:0xf bank_mask:0x3
    v_perm_b32 v168, v197, v193, s8
    v_perm_b32 v24, v197, v193, s8
    v_perm_b32 v184, v199, v195, s8
    v_perm_b32 v169, v205, v201, s8
    v_perm_b32 v25, v205, v201, s8
    v_perm_b32 v185, v207, v203, s8
    v_perm_b32 v170, v213, v209, s8
    v_perm_b32 v26, v213, v209, s8
    v_perm_b32 v186, v215, v211, s8
    v_perm_b32 v171, v221, v217, s8
    v_perm_b32 v27, v221, v217, s8
    v_perm_b32 v187, v223, v219, s8
    v_mov_b32_dpp v168, v184 row_ror:8 row_mask:0xf bank_mask:0xc
    v_mov_b32_dpp v169, v185 row_ror:8 row_mask:0xf bank_mask:0xc
    v_mov_b32_dpp v170, v186 row_ror:8 row_mask:0xf bank_mask:0xc
    v_mov_b32_dpp v171, v187 row_ror:8 row_mask:0xf bank_mask:0xc
    v_mov_b32_dpp v184, v24 row_ror:8 row_mask:0xf bank_mask:0x3
    v_mov_b32_dpp v185, v25 row_ror:8 row_mask:0xf bank_mask:0x3
    v_mov_b32_dpp v186, v26 row_ror:8 row_mask:0xf bank_mask:0x3
    v_mov_b32_dpp v187, v27 row_ror:8 row_mask:0xf bank_mask:0x3
    v_perm_b32 v172, v197, v193, s9
    v_perm_b32 v24, v197, v193, s9
    v_perm_b32 v188, v199, v195, s9
    v_perm_b32 v173, v205, v201, s9
    v_perm_b32 v25, v205, v201, s9
    v_perm_b32 v189, v207, v203, s9
    v_perm_b32 v174, v213, v209, s9
    v_perm_b32 v26, v213, v209, s9
    v_perm_b32 v190, v215, v211, s9
    v_perm_b32 v175, v221, v217, s9
    v_perm_b32 v27, v221, v217, s9
    v_perm_b32 v191, v223, v219, s9
    v_mov_b32_dpp v172, v188 row_ror:8 row_mask:0xf bank_mask:0xc
    v_mov_b32_dpp v173, v189 row_ror:8 row_mask:0xf bank_mask:0xc
    v_mov_b32_dpp v174, v190 row_ror:8 row_mask:0xf bank_mask:0xc
    v_mov_b32_dpp v175, v191 row_ror:8 row_mask:0xf bank_mask:0xc
    v_mov_b32_dpp v188, v24 row_ror:8 row_mask:0xf bank_mask:0x3
    v_mov_b32_dpp v189, v25 row_ror:8 row_mask:0xf bank_mask:0x3
    v_mov_b32_dpp v190, v26 row_ror:8 row_mask:0xf bank_mask:0x3
    v_mov_b32_dpp v191, v27 row_ror:8 row_mask:0xf bank_mask:0x3
    v_perm_b32 v192, v228, v224, s8
    v_perm_b32 v24, v228, v224, s8
    v_perm_b32 v208, v230, v226, s8
    v_perm_b32 v193, v236, v232, s8
    v_perm_b32 v25, v236, v232, s8
    v_perm_b32 v209, v238, v234, s8
    v_perm_b32 v194, v244, v240, s8
    v_perm_b32 v26, v244, v240, s8
    v_perm_b32 v210, v246, v242, s8
    v_perm_b32 v195, v252, v248, s8
    v_perm_b32 v27, v252, v248, s8
    v_perm_b32 v211, v254, v250, s8
    v_mov_b32_dpp v192, v208 row_ror:8 row_mask:0xf bank_mask:0xc
    v_mov_b32_dpp v193, v209 row_ror:8 row_mask:0xf bank_mask:0xc
    v_mov_b32_dpp v194, v210 row_ror:8 row_mask:0xf bank_mask:0xc
    v_mov_b32_dpp v195, v211 row_ror:8 row_mask:0xf bank_mask:0xc
    v_mov_b32_dpp v208, v24 row_ror:8 row_mask:0xf bank_mask:0x3
    v_mov_b32_dpp v209, v25 row_ror:8 row_mask:0xf bank_mask:0x3
    v_mov_b32_dpp v210, v26 row_ror:8 row_mask:0xf bank_mask:0x3
    v_mov_b32_dpp v211, v27 row_ror:8 row_mask:0xf bank_mask:0x3
    v_perm_b32 v196, v228, v224, s9
    v_perm_b32 v24, v228, v224, s9
    v_perm_b32 v212, v230, v226, s9
    v_perm_b32 v197, v236, v232, s9
    v_perm_b32 v25, v236, v232, s9
    v_perm_b32 v213, v238, v234, s9
    v_perm_b32 v198, v244, v240, s9
    v_perm_b32 v26, v244, v240, s9
    v_perm_b32 v214, v246, v242, s9
    v_perm_b32 v199, v252, v248, s9
    v_perm_b32 v27, v252, v248, s9
    v_perm_b32 v215, v254, v250, s9
    v_mov_b32_dpp v196, v212 row_ror:8 row_mask:0xf bank_mask:0xc
    v_mov_b32_dpp v197, v213 row_ror:8 row_mask:0xf bank_mask:0xc
    v_mov_b32_dpp v198, v214 row_ror:8 row_mask:0xf bank_mask:0xc
    v_mov_b32_dpp v199, v215 row_ror:8 row_mask:0xf bank_mask:0xc
    v_mov_b32_dpp v212, v24 row_ror:8 row_mask:0xf bank_mask:0x3
    v_mov_b32_dpp v213, v25 row_ror:8 row_mask:0xf bank_mask:0x3
    v_mov_b32_dpp v214, v26 row_ror:8 row_mask:0xf bank_mask:0x3
    v_mov_b32_dpp v215, v27 row_ror:8 row_mask:0xf bank_mask:0x3
    v_perm_b32 v200, v229, v225, s8
    v_perm_b32 v24, v229, v225, s8
    v_perm_b32 v216, v231, v227, s8
    v_perm_b32 v201, v237, v233, s8
    v_perm_b32 v25, v237, v233, s8
    v_perm_b32 v217, v239, v235, s8
    v_perm_b32 v202, v245, v241, s8
    v_perm_b32 v26, v245, v241, s8
    v_perm_b32 v218, v247, v243, s8
    v_perm_b32 v203, v253, v249, s8
    v_perm_b32 v27, v253, v249, s8
    v_perm_b32 v219, v255, v251, s8
    v_mov_b32_dpp v200, v216 row_ror:8 row_mask:0xf bank_mask:0xc
    v_mov_b32_dpp v201, v217 row_ror:8 row_mask:0xf bank_mask:0xc
    v_mov_b32_dpp v202, v218 row_ror:8 row_mask:0xf bank_mask:0xc
    v_mov_b32_dpp v203, v219 row_ror:8 row_mask:0xf bank_mask:0xc
    v_mov_b32_dpp v216, v24 row_ror:8 row_mask:0xf bank_mask:0x3
    v_mov_b32_dpp v217, v25 row_ror:8 row_mask:0xf bank_mask:0x3
    v_mov_b32_dpp v218, v26 row_ror:8 row_mask:0xf bank_mask:0x3
    v_mov_b32_dpp v219, v27 row_ror:8 row_mask:0xf bank_mask:0x3
    v_perm_b32 v204, v229, v225, s9
    v_perm_b32 v24, v229, v225, s9
    v_perm_b32 v220, v231, v227, s9
    v_perm_b32 v205, v237, v233, s9
    v_perm_b32 v25, v237, v233, s9
    v_perm_b32 v221, v239, v235, s9
    v_perm_b32 v206, v245, v241, s9
    v_perm_b32 v26, v245, v241, s9
    v_perm_b32 v222, v247, v243, s9
    v_perm_b32 v207, v253, v249, s9
    v_perm_b32 v27, v253, v249, s9
    v_perm_b32 v223, v255, v251, s9
    v_mov_b32_dpp v204, v220 row_ror:8 row_mask:0xf bank_mask:0xc
    v_mov_b32_dpp v205, v221 row_ror:8 row_mask:0xf bank_mask:0xc
    v_mov_b32_dpp v206, v222 row_ror:8 row_mask:0xf bank_mask:0xc
    v_mov_b32_dpp v207, v223 row_ror:8 row_mask:0xf bank_mask:0xc
    v_mov_b32_dpp v220, v24 row_ror:8 row_mask:0xf bank_mask:0x3
    v_mov_b32_dpp v221, v25 row_ror:8 row_mask:0xf bank_mask:0x3
    v_mov_b32_dpp v222, v26 row_ror:8 row_mask:0xf bank_mask:0x3
    v_mov_b32_dpp v223, v27 row_ror:8 row_mask:0xf bank_mask:0x3
    v_perm_b32 v224, v96, v92, s8
    v_perm_b32 v24, v96, v92, s8
    v_perm_b32 v240, v98, v94, s8
    v_perm_b32 v225, v104, v100, s8
    v_perm_b32 v25, v104, v100, s8
    v_perm_b32 v241, v106, v102, s8
    v_perm_b32 v226, v112, v108, s8
    v_perm_b32 v26, v112, v108, s8
    v_perm_b32 v242, v114, v110, s8
    v_perm_b32 v227, v120, v116, s8
    v_perm_b32 v27, v120, v116, s8
    v_perm_b32 v243, v122, v118, s8
    v_mov_b32_dpp v224, v240 row_ror:8 row_mask:0xf bank_mask:0xc
    v_mov_b32_dpp v225, v241 row_ror:8 row_mask:0xf bank_mask:0xc
    v_mov_b32_dpp v226, v242 row_ror:8 row_mask:0xf bank_mask:0xc
    v_mov_b32_dpp v227, v243 row_ror:8 row_mask:0xf bank_mask:0xc
    v_mov_b32_dpp v240, v24 row_ror:8 row_mask:0xf bank_mask:0x3
    v_mov_b32_dpp v241, v25 row_ror:8 row_mask:0xf bank_mask:0x3
    v_mov_b32_dpp v242, v26 row_ror:8 row_mask:0xf bank_mask:0x3
    v_mov_b32_dpp v243, v27 row_ror:8 row_mask:0xf bank_mask:0x3
    v_perm_b32 v228, v96, v92, s9
    v_perm_b32 v24, v96, v92, s9
    v_perm_b32 v244, v98, v94, s9
    v_perm_b32 v229, v104, v100, s9
    v_perm_b32 v25, v104, v100, s9
    v_perm_b32 v245, v106, v102, s9
    v_perm_b32 v230, v112, v108, s9
    v_perm_b32 v26, v112, v108, s9
    v_perm_b32 v246, v114, v110, s9
    v_perm_b32 v231, v120, v116, s9
    v_perm_b32 v27, v120, v116, s9
    v_perm_b32 v247, v122, v118, s9
    v_mov_b32_dpp v228, v244 row_ror:8 row_mask:0xf bank_mask:0xc
    v_mov_b32_dpp v229, v245 row_ror:8 row_mask:0xf bank_mask:0xc
    v_mov_b32_dpp v230, v246 row_ror:8 row_mask:0xf bank_mask:0xc
    v_mov_b32_dpp v231, v247 row_ror:8 row_mask:0xf bank_mask:0xc
    v_mov_b32_dpp v244, v24 row_ror:8 row_mask:0xf bank_mask:0x3
    v_mov_b32_dpp v245, v25 row_ror:8 row_mask:0xf bank_mask:0x3
    v_mov_b32_dpp v246, v26 row_ror:8 row_mask:0xf bank_mask:0x3
    v_mov_b32_dpp v247, v27 row_ror:8 row_mask:0xf bank_mask:0x3
    v_perm_b32 v232, v97, v93, s8
    v_perm_b32 v24, v97, v93, s8
    v_perm_b32 v248, v99, v95, s8
    v_perm_b32 v233, v105, v101, s8
    v_perm_b32 v25, v105, v101, s8
    v_perm_b32 v249, v107, v103, s8
    v_perm_b32 v234, v113, v109, s8
    v_perm_b32 v26, v113, v109, s8
    v_perm_b32 v250, v115, v111, s8
    v_perm_b32 v235, v121, v117, s8
    v_perm_b32 v27, v121, v117, s8
    v_perm_b32 v251, v123, v119, s8
    v_mov_b32_dpp v232, v248 row_ror:8 row_mask:0xf bank_mask:0xc
    v_mov_b32_dpp v233, v249 row_ror:8 row_mask:0xf bank_mask:0xc
    v_mov_b32_dpp v234, v250 row_ror:8 row_mask:0xf bank_mask:0xc
    v_mov_b32_dpp v235, v251 row_ror:8 row_mask:0xf bank_mask:0xc
    v_mov_b32_dpp v248, v24 row_ror:8 row_mask:0xf bank_mask:0x3
    v_mov_b32_dpp v249, v25 row_ror:8 row_mask:0xf bank_mask:0x3
    v_mov_b32_dpp v250, v26 row_ror:8 row_mask:0xf bank_mask:0x3
    v_mov_b32_dpp v251, v27 row_ror:8 row_mask:0xf bank_mask:0x3
    v_perm_b32 v236, v97, v93, s9
    v_perm_b32 v24, v97, v93, s9
    v_perm_b32 v252, v99, v95, s9
    v_perm_b32 v237, v105, v101, s9
    v_perm_b32 v25, v105, v101, s9
    v_perm_b32 v253, v107, v103, s9
    v_perm_b32 v238, v113, v109, s9
    v_perm_b32 v26, v113, v109, s9
    v_perm_b32 v254, v115, v111, s9
    v_perm_b32 v239, v121, v117, s9
    v_perm_b32 v27, v121, v117, s9
    v_perm_b32 v255, v123, v119, s9
    v_mov_b32_dpp v236, v252 row_ror:8 row_mask:0xf bank_mask:0xc
    v_mov_b32_dpp v237, v253 row_ror:8 row_mask:0xf bank_mask:0xc
    v_mov_b32_dpp v238, v254 row_ror:8 row_mask:0xf bank_mask:0xc
    v_mov_b32_dpp v239, v255 row_ror:8 row_mask:0xf bank_mask:0xc
    v_mov_b32_dpp v252, v24 row_ror:8 row_mask:0xf bank_mask:0x3
    v_mov_b32_dpp v253, v25 row_ror:8 row_mask:0xf bank_mask:0x3
    v_mov_b32_dpp v254, v26 row_ror:8 row_mask:0xf bank_mask:0x3
    v_mov_b32_dpp v255, v27 row_ror:8 row_mask:0xf bank_mask:0x3
    s_setprio 2
L_noperm:
    s_waitcnt lgkmcnt(0)
    v_lshrrev_b32 v2, 5, v1
    v_mul_u32_u24 v6, 7168, v2
    v_bfe_u32 v2, v1, 4, 1
    v_lshlrev_b32 v2, 9, v2
    v_and_b32 v3, 15, v1
    v_lshlrev_b32 v3, 4, v3
    v_add3_u32 v6, v6, v2, v3
    s_mul_i32 s15, s18, 229376
    s_mul_i32 s3, s64, 28672
    s_add_u32 s15, s15, s3
    v_add_u32 v6, s15, v6
    v_add_u32 v7, 114688, v6
    s_lshr_b32 s15, s18, 1
    s_lshl_b32 s15, s15, 6
    s_and_b32 s3, s18, 1
    s_lshl_b32 s3, s3, 1
    s_add_u32 s15, s15, s3
    v_bfe_u32 v2, v1, 1, 4
    v_and_b32 v3, 1, v1
    v_lshl_add_u32 v2, v2, 2, v3
    v_add_u32 v2, s15, v2
    v_lshlrev_b32 v2, 7, v2
    v_add_u32 v120, 262144, v2
    s_lshl_b32 s63, s7, 3
    s_mov_b32 s62, 0
    s_cmp_eq_u32 s64, 1
    s_cselect_b32 s62, 125184, s62
    s_cmp_eq_u32 s64, 2
    s_cselect_b32 s62, 29184, s62
    s_cmp_eq_u32 s64, 3
    s_cselect_b32 s62, 66816, s62
    v_lshl_add_u32 v121, v1, 4, s62
    s_barrier
    v_lshlrev_b32 v4, 4, v1
    s_sub_u32 s15, s6, 4
    s_lshl_b32 s15, s15, 10
    s_add_u32 m0, s15, 66816
    s_add_u32 s3, s15, 145920
    buffer_load_dwordx4 v4, s[56:59], s3 offen sc1 lds
    s_add_u32 m0, s15, 70912
    s_add_u32 s3, s15, 150016
    buffer_load_dwordx4 v4, s[56:59], s3 offen sc1 lds
    s_add_u32 m0, s15, 75008
    s_add_u32 s3, s15, 154112
    buffer_load_dwordx4 v4, s[56:59], s3 offen sc1 lds
    s_add_u32 m0, s15, 79104
    s_add_u32 s3, s15, 158208
    buffer_load_dwordx4 v4, s[56:59], s3 offen sc1 lds
    s_add_u32 m0, s15, 83200
    s_add_u32 s3, s15, 162304
    buffer_load_dwordx4 v4, s[56:59], s3 offen sc1 lds
    s_add_u32 m0, s15, 87296
    s_add_u32 s3, s15, 166400
    buffer_load_dwordx4 v4, s[56:59], s3 offen sc1 lds
    s_add_u32 m0, s15, 91392
    s_add_u32 s3, s15, 170496
    buffer_load_dwordx4 v4, s[56:59], s3 offen sc1 lds
    s_add_u32 m0, s15, 95488
    s_add_u32 s3, s15, 174592
    buffer_load_dwordx4 v4, s[56:59], s3 offen sc1 lds
    s_add_u32 m0, s15, 99584
    s_add_u32 s3, s15, 178688
    buffer_load_dwordx4 v4, s[56:59], s3 offen sc1 lds
    s_add_u32 m0, s15, 103680
    s_add_u32 s3, s15, 182784
    buffer_load_dwordx4 v4, s[56:59], s3 offen sc1 lds
    s_add_u32 m0, s15, 107776
    s_add_u32 s3, s15, 186880
    buffer_load_dwordx4 v4, s[56:59], s3 offen sc1 lds
    s_add_u32 m0, s15, 111872
    s_add_u32 s3, s15, 190976
    buffer_load_dwordx4 v4, s[56:59], s3 offen sc1 lds
    s_add_u32 m0, s15, 115968
    s_add_u32 s3, s15, 195072
    buffer_load_dwordx4 v4, s[56:59], s3 offen sc1 lds
    s_add_u32 m0, s15, 120064
    s_add_u32 s3, s15, 199168
    buffer_load_dwordx4 v4, s[56:59], s3 offen sc1 lds
    s_add_u32 m0, s15, 124160
    s_add_u32 s3, s15, 203264
    s_cmp_lt_u32 s6, 5
    s_cbranch_scc0 dma_49
    buffer_load_dwordx4 v4, s[56:59], s3 offen sc1 lds
dma_49:
    s_mov_b32 exec_hi, -1
    s_waitcnt vmcnt(0)
    s_barrier
    s_cmp_lt_u32 s5, 28
    s_cbranch_scc0 L_fin
    s_setprio 0
    s_mov_b32 s15, 57344
    buffer_load_dwordx4 v[8:11], v127, s[20:23], s15 offen
    s_mov_b32 s15, 60928
    buffer_load_dwordx4 v[12:15], v127, s[20:23], s15 offen
    s_mov_b32 s15, 64512
    buffer_load_dwordx4 v[16:19], v127, s[20:23], s15 offen
    s_mov_b32 s15, 68096
    buffer_load_dwordx4 v[20:23], v127, s[20:23], s15 offen
    s_mov_b32 s15, 59136
    buffer_load_dwordx4 v[24:27], v127, s[20:23], s15 offen
    s_mov_b32 s15, 62720
    buffer_load_dwordx4 v[28:31], v127, s[20:23], s15 offen
    s_mov_b32 s15, 66304
    buffer_load_dwordx4 v[32:35], v127, s[20:23], s15 offen
    s_mov_b32 s15, 69888
    buffer_load_dwordx4 v[36:39], v127, s[20:23], s15 offen
    s_mov_b32 s15, 71680
    buffer_load_dwordx4 v[40:43], v127, s[20:23], s15 offen
    s_mov_b32 s15, 75264
    buffer_load_dwordx4 v[44:47], v127, s[20:23], s15 offen
    s_mov_b32 s15, 78848
    buffer_load_dwordx4 v[48:51], v127, s[20:23], s15 offen
    s_mov_b32 s15, 82432
    buffer_load_dwordx4 v[52:55], v127, s[20:23], s15 offen
    s_mov_b32 s15, 73472
    buffer_load_dwordx4 v[56:59], v127, s[20:23], s15 offen
    s_mov_b32 s15, 77056
    buffer_load_dwordx4 v[60:63], v127, s[20:23], s15 offen
    s_mov_b32 s15, 80640
    buffer_load_dwordx4 v[64:67], v127, s[20:23], s15 offen
    s_mov_b32 s15, 84224
    buffer_load_dwordx4 v[68:71], v127, s[20:23], s15 offen
    s_cmp_lt_u32 s64, 2
    s_cbranch_scc1 L_slotok
    s_lshl_b32 s3, s64, 4
    s_add_u32 s60, s3, 160816
    s_mov_b32 s65, 0
    v_mov_b32 v2, s60
lf_50:
    ds_read_b128 v[104:107], v2
    s_waitcnt lgkmcnt(0)
    v_and_b32 v104, v104, v105
    v_and_b32 v106, v106, v107
    v_and_b32 v104, v104, v106
    v_cmp_eq_u32 vcc, 0, v104
    s_cbranch_vccz lfd_51
    s_add_u32 s65, s65, 1
    s_cmp_lt_u32 s65, 400000
    s_cbranch_scc1 lf_50
lfd_51:
L_slotok:
    s_mov_b32 s8, 0x05040100
    s_mov_b32 s9, 0x07060302
    s_waitcnt vmcnt(8) lgkmcnt(0)
    v_perm_b32 v72, v12, v8, s8
    v_perm_b32 v104, v12, v8, s8
    v_perm_b32 v88, v14, v10, s8
    v_perm_b32 v73, v20, v16, s8
    v_perm_b32 v105, v20, v16, s8
    v_perm_b32 v89, v22, v18, s8
    v_perm_b32 v74, v28, v24, s8
    v_perm_b32 v106, v28, v24, s8
    v_perm_b32 v90, v30, v26, s8
    v_perm_b32 v75, v36, v32, s8
    v_perm_b32 v107, v36, v32, s8
    v_perm_b32 v91, v38, v34, s8
    v_mov_b32_dpp v72, v88 row_ror:8 row_mask:0xf bank_mask:0xc
    v_mov_b32_dpp v73, v89 row_ror:8 row_mask:0xf bank_mask:0xc
    v_mov_b32_dpp v74, v90 row_ror:8 row_mask:0xf bank_mask:0xc
    v_mov_b32_dpp v75, v91 row_ror:8 row_mask:0xf bank_mask:0xc
    v_mov_b32_dpp v88, v104 row_ror:8 row_mask:0xf bank_mask:0x3
    v_mov_b32_dpp v89, v105 row_ror:8 row_mask:0xf bank_mask:0x3
    v_mov_b32_dpp v90, v106 row_ror:8 row_mask:0xf bank_mask:0x3
    v_mov_b32_dpp v91, v107 row_ror:8 row_mask:0xf bank_mask:0x3
    v_perm_b32 v76, v12, v8, s9
    v_perm_b32 v104, v12, v8, s9
    v_perm_b32 v92, v14, v10, s9
    v_perm_b32 v77, v20, v16, s9
    v_perm_b32 v105, v20, v16, s9
    v_perm_b32 v93, v22, v18, s9
    v_perm_b32 v78, v28, v24, s9
    v_perm_b32 v106, v28, v24, s9
    v_perm_b32 v94, v30, v26, s9
    v_perm_b32 v79, v36, v32, s9
    v_perm_b32 v107, v36, v32, s9
    v_perm_b32 v95, v38, v34, s9
    v_mov_b32_dpp v76, v92 row_ror:8 row_mask:0xf bank_mask:0xc
    v_mov_b32_dpp v77, v93 row_ror:8 row_mask:0xf bank_mask:0xc
    v_mov_b32_dpp v78, v94 row_ror:8 row_mask:0xf bank_mask:0xc
    v_mov_b32_dpp v79, v95 row_ror:8 row_mask:0xf bank_mask:0xc
    v_mov_b32_dpp v92, v104 row_ror:8 row_mask:0xf bank_mask:0x3
    v_mov_b32_dpp v93, v105 row_ror:8 row_mask:0xf bank_mask:0x3
    v_mov_b32_dpp v94, v106 row_ror:8 row_mask:0xf bank_mask:0x3
    v_mov_b32_dpp v95, v107 row_ror:8 row_mask:0xf bank_mask:0x3
    v_perm_b32 v80, v13, v9, s8
    v_perm_b32 v104, v13, v9, s8
    v_perm_b32 v96, v15, v11, s8
    v_perm_b32 v81, v21, v17, s8
    v_perm_b32 v105, v21, v17, s8
    v_perm_b32 v97, v23, v19, s8
    v_perm_b32 v82, v29, v25, s8
    v_perm_b32 v106, v29, v25, s8
    v_perm_b32 v98, v31, v27, s8
    v_perm_b32 v83, v37, v33, s8
    v_perm_b32 v107, v37, v33, s8
    v_perm_b32 v99, v39, v35, s8
    v_mov_b32_dpp v80, v96 row_ror:8 row_mask:0xf bank_mask:0xc
    v_mov_b32_dpp v81, v97 row_ror:8 row_mask:0xf bank_mask:0xc
    v_mov_b32_dpp v82, v98 row_ror:8 row_mask:0xf bank_mask:0xc
    v_mov_b32_dpp v83, v99 row_ror:8 row_mask:0xf bank_mask:0xc
    v_mov_b32_dpp v96, v104 row_ror:8 row_mask:0xf bank_mask:0x3
    v_mov_b32_dpp v97, v105 row_ror:8 row_mask:0xf bank_mask:0x3
    v_mov_b32_dpp v98, v106 row_ror:8 row_mask:0xf bank_mask:0x3
    v_mov_b32_dpp v99, v107 row_ror:8 row_mask:0xf bank_mask:0x3
    v_perm_b32 v84, v13, v9, s9
    v_perm_b32 v104, v13, v9, s9
    v_perm_b32 v100, v15, v11, s9
    v_perm_b32 v85, v21, v17, s9
    v_perm_b32 v105, v21, v17, s9
    v_perm_b32 v101, v23, v19, s9
    v_perm_b32 v86, v29, v25, s9
    v_perm_b32 v106, v29, v25, s9
    v_perm_b32 v102, v31, v27, s9
    v_perm_b32 v87, v37, v33, s9
    v_perm_b32 v107, v37, v33, s9
    v_perm_b32 v103, v39, v35, s9
    v_mov_b32_dpp v84, v100 row_ror:8 row_mask:0xf bank_mask:0xc
    v_mov_b32_dpp v85, v101 row_ror:8 row_mask:0xf bank_mask:0xc
    v_mov_b32_dpp v86, v102 row_ror:8 row_mask:0xf bank_mask:0xc
    v_mov_b32_dpp v87, v103 row_ror:8 row_mask:0xf bank_mask:0xc
    v_mov_b32_dpp v100, v104 row_ror:8 row_mask:0xf bank_mask:0x3
    v_mov_b32_dpp v101, v105 row_ror:8 row_mask:0xf bank_mask:0x3
    v_mov_b32_dpp v102, v106 row_ror:8 row_mask:0xf bank_mask:0x3
    v_mov_b32_dpp v103, v107 row_ror:8 row_mask:0xf bank_mask:0x3
    s_mov_b32 s15, 86016
    buffer_load_dwordx4 v[8:11], v127, s[20:23], s15 offen
    s_mov_b32 s15, 89600
    buffer_load_dwordx4 v[12:15], v127, s[20:23], s15 offen
    s_mov_b32 s15, 93184
    buffer_load_dwordx4 v[16:19], v127, s[20:23], s15 offen
    s_mov_b32 s15, 96768
    buffer_load_dwordx4 v[20:23], v127, s[20:23], s15 offen
    s_mov_b32 s15, 87808
    buffer_load_dwordx4 v[24:27], v127, s[20:23], s15 offen
    s_mov_b32 s15, 91392
    buffer_load_dwordx4 v[28:31], v127, s[20:23], s15 offen
    s_mov_b32 s15, 94976
    buffer_load_dwordx4 v[32:35], v127, s[20:23], s15 offen
    s_mov_b32 s15, 98560
    buffer_load_dwordx4 v[36:39], v127, s[20:23], s15 offen
    ds_write_b128 v121, v[72:75] offset:0
    ds_write_b128 v121, v[76:79] offset:1024
    ds_write_b128 v121, v[80:83] offset:2048
    ds_write_b128 v121, v[84:87] offset:3072
    ds_write_b128 v121, v[88:91] offset:4096
    ds_write_b128 v121, v[92:95] offset:5120
    ds_write_b128 v121, v[96:99] offset:6144
    ds_write_b128 v121, v[100:103] offset:7168
    s_waitcnt vmcnt(8) lgkmcnt(0)
    v_perm_b32 v72, v44, v40, s8
    v_perm_b32 v104, v44, v40, s8
    v_perm_b32 v88, v46, v42, s8
    v_perm_b32 v73, v52, v48, s8
    v_perm_b32 v105, v52, v48, s8
    v_perm_b32 v89, v54, v50, s8
    v_perm_b32 v74, v60, v56, s8
    v_perm_b32 v106, v60, v56, s8
    v_perm_b32 v90, v62, v58, s8
    v_perm_b32 v75, v68, v64, s8
    v_perm_b32 v107, v68, v64, s8
    v_perm_b32 v91, v70, v66, s8
    v_mov_b32_dpp v72, v88 row_ror:8 row_mask:0xf bank_mask:0xc
    v_mov_b32_dpp v73, v89 row_ror:8 row_mask:0xf bank_mask:0xc
    v_mov_b32_dpp v74, v90 row_ror:8 row_mask:0xf bank_mask:0xc
    v_mov_b32_dpp v75, v91 row_ror:8 row_mask:0xf bank_mask:0xc
    v_mov_b32_dpp v88, v104 row_ror:8 row_mask:0xf bank_mask:0x3
    v_mov_b32_dpp v89, v105 row_ror:8 row_mask:0xf bank_mask:0x3
    v_mov_b32_dpp v90, v106 row_ror:8 row_mask:0xf bank_mask:0x3
    v_mov_b32_dpp v91, v107 row_ror:8 row_mask:0xf bank_mask:0x3
    v_perm_b32 v76, v44, v40, s9
    v_perm_b32 v104, v44, v40, s9
    v_perm_b32 v92, v46, v42, s9
    v_perm_b32 v77, v52, v48, s9
    v_perm_b32 v105, v52, v48, s9
    v_perm_b32 v93, v54, v50, s9
    v_perm_b32 v78, v60, v56, s9
    v_perm_b32 v106, v60, v56, s9
    v_perm_b32 v94, v62, v58, s9
    v_perm_b32 v79, v68, v64, s9
    v_perm_b32 v107, v68, v64, s9
    v_perm_b32 v95, v70, v66, s9
    v_mov_b32_dpp v76, v92 row_ror:8 row_mask:0xf bank_mask:0xc
    v_mov_b32_dpp v77, v93 row_ror:8 row_mask:0xf bank_mask:0xc
    v_mov_b32_dpp v78, v94 row_ror:8 row_mask:0xf bank_mask:0xc
    v_mov_b32_dpp v79, v95 row_ror:8 row_mask:0xf bank_mask:0xc
    v_mov_b32_dpp v92, v104 row_ror:8 row_mask:0xf bank_mask:0x3
    v_mov_b32_dpp v93, v105 row_ror:8 row_mask:0xf bank_mask:0x3
    v_mov_b32_dpp v94, v106 row_ror:8 row_mask:0xf bank_mask:0x3
    v_mov_b32_dpp v95, v107 row_ror:8 row_mask:0xf bank_mask:0x3
    v_perm_b32 v80, v45, v41, s8
    v_perm_b32 v104, v45, v41, s8
    v_perm_b32 v96, v47, v43, s8
    v_perm_b32 v81, v53, v49, s8
    v_perm_b32 v105, v53, v49, s8
    v_perm_b32 v97, v55, v51, s8
    v_perm_b32 v82, v61, v57, s8
    v_perm_b32 v106, v61, v57, s8
    v_perm_b32 v98, v63, v59, s8
    v_perm_b32 v83, v69, v65, s8
    v_perm_b32 v107, v69, v65, s8
    v_perm_b32 v99, v71, v67, s8
    v_mov_b32_dpp v80, v96 row_ror:8 row_mask:0xf bank_mask:0xc
    v_mov_b32_dpp v81, v97 row_ror:8 row_mask:0xf bank_mask:0xc
    v_mov_b32_dpp v82, v98 row_ror:8 row_mask:0xf bank_mask:0xc
    v_mov_b32_dpp v83, v99 row_ror:8 row_mask:0xf bank_mask:0xc
    v_mov_b32_dpp v96, v104 row_ror:8 row_mask:0xf bank_mask:0x3
    v_mov_b32_dpp v97, v105 row_ror:8 row_mask:0xf bank_mask:0x3
    v_mov_b32_dpp v98, v106 row_ror:8 row_mask:0xf bank_mask:0x3
    v_mov_b32_dpp v99, v107 row_ror:8 row_mask:0xf bank_mask:0x3
    v_perm_b32 v84, v45, v41, s9
    v_perm_b32 v104, v45, v41, s9
    v_perm_b32 v100, v47, v43, s9
    v_perm_b32 v85, v53, v49, s9
    v_perm_b32 v105, v53, v49, s9
    v_perm_b32 v101, v55, v51, s9
    v_perm_b32 v86, v61, v57, s9
    v_perm_b32 v106, v61, v57, s9
    v_perm_b32 v102, v63, v59, s9
    v_perm_b32 v87, v69, v65, s9
    v_perm_b32 v107, v69, v65, s9
    v_perm_b32 v103, v71, v67, s9
    v_mov_b32_dpp v84, v100 row_ror:8 row_mask:0xf bank_mask:0xc
    v_mov_b32_dpp v85, v101 row_ror:8 row_mask:0xf bank_mask:0xc
    v_mov_b32_dpp v86, v102 row_ror:8 row_mask:0xf bank_mask:0xc
    v_mov_b32_dpp v87, v103 row_ror:8 row_mask:0xf bank_mask:0xc
    v_mov_b32_dpp v100, v104 row_ror:8 row_mask:0xf bank_mask:0x3
    v_mov_b32_dpp v101, v105 row_ror:8 row_mask:0xf bank_mask:0x3
    v_mov_b32_dpp v102, v106 row_ror:8 row_mask:0xf bank_mask:0x3
    v_mov_b32_dpp v103, v107 row_ror:8 row_mask:0xf bank_mask:0x3
    ds_write_b128 v121, v[72:75] offset:8192
    ds_write_b128 v121, v[76:79] offset:9216
    ds_write_b128 v121, v[80:83] offset:10240
    ds_write_b128 v121, v[84:87] offset:11264
    ds_write_b128 v121, v[88:91] offset:12288
    ds_write_b128 v121, v[92:95] offset:13312
    ds_write_b128 v121, v[96:99] offset:14336
    ds_write_b128 v121, v[100:103] offset:15360
    s_waitcnt vmcnt(0) lgkmcnt(0)
    v_perm_b32 v72, v12, v8, s8
    v_perm_b32 v104, v12, v8, s8
    v_perm_b32 v88, v14, v10, s8
    v_perm_b32 v73, v20, v16, s8
    v_perm_b32 v105, v20, v16, s8
    v_perm_b32 v89, v22, v18, s8
    v_perm_b32 v74, v28, v24, s8
    v_perm_b32 v106, v28, v24, s8
    v_perm_b32 v90, v30, v26, s8
    v_perm_b32 v75, v36, v32, s8
    v_perm_b32 v107, v36, v32, s8
    v_perm_b32 v91, v38, v34, s8
    v_mov_b32_dpp v72, v88 row_ror:8 row_mask:0xf bank_mask:0xc
    v_mov_b32_dpp v73, v89 row_ror:8 row_mask:0xf bank_mask:0xc
    v_mov_b32_dpp v74, v90 row_ror:8 row_mask:0xf bank_mask:0xc
    v_mov_b32_dpp v75, v91 row_ror:8 row_mask:0xf bank_mask:0xc
    v_mov_b32_dpp v88, v104 row_ror:8 row_mask:0xf bank_mask:0x3
    v_mov_b32_dpp v89, v105 row_ror:8 row_mask:0xf bank_mask:0x3
    v_mov_b32_dpp v90, v106 row_ror:8 row_mask:0xf bank_mask:0x3
    v_mov_b32_dpp v91, v107 row_ror:8 row_mask:0xf bank_mask:0x3
    v_perm_b32 v76, v12, v8, s9
    v_perm_b32 v104, v12, v8, s9
    v_perm_b32 v92, v14, v10, s9
    v_perm_b32 v77, v20, v16, s9
    v_perm_b32 v105, v20, v16, s9
    v_perm_b32 v93, v22, v18, s9
    v_perm_b32 v78, v28, v24, s9
    v_perm_b32 v106, v28, v24, s9
    v_perm_b32 v94, v30, v26, s9
    v_perm_b32 v79, v36, v32, s9
    v_perm_b32 v107, v36, v32, s9
    v_perm_b32 v95, v38, v34, s9
    v_mov_b32_dpp v76, v92 row_ror:8 row_mask:0xf bank_mask:0xc
    v_mov_b32_dpp v77, v93 row_ror:8 row_mask:0xf bank_mask:0xc
    v_mov_b32_dpp v78, v94 row_ror:8 row_mask:0xf bank_mask:0xc
    v_mov_b32_dpp v79, v95 row_ror:8 row_mask:0xf bank_mask:0xc
    v_mov_b32_dpp v92, v104 row_ror:8 row_mask:0xf bank_mask:0x3
    v_mov_b32_dpp v93, v105 row_ror:8 row_mask:0xf bank_mask:0x3
    v_mov_b32_dpp v94, v106 row_ror:8 row_mask:0xf bank_mask:0x3
    v_mov_b32_dpp v95, v107 row_ror:8 row_mask:0xf bank_mask:0x3
    v_perm_b32 v80, v13, v9, s8
    v_perm_b32 v104, v13, v9, s8
    v_perm_b32 v96, v15, v11, s8
    v_perm_b32 v81, v21, v17, s8
    v_perm_b32 v105, v21, v17, s8
    v_perm_b32 v97, v23, v19, s8
    v_perm_b32 v82, v29, v25, s8
    v_perm_b32 v106, v29, v25, s8
    v_perm_b32 v98, v31, v27, s8
    v_perm_b32 v83, v37, v33, s8
    v_perm_b32 v107, v37, v33, s8
    v_perm_b32 v99, v39, v35, s8
    v_mov_b32_dpp v80, v96 row_ror:8 row_mask:0xf bank_mask:0xc
    v_mov_b32_dpp v81, v97 row_ror:8 row_mask:0xf bank_mask:0xc
    v_mov_b32_dpp v82, v98 row_ror:8 row_mask:0xf bank_mask:0xc
    v_mov_b32_dpp v83, v99 row_ror:8 row_mask:0xf bank_mask:0xc
    v_mov_b32_dpp v96, v104 row_ror:8 row_mask:0xf bank_mask:0x3
    v_mov_b32_dpp v97, v105 row_ror:8 row_mask:0xf bank_mask:0x3
    v_mov_b32_dpp v98, v106 row_ror:8 row_mask:0xf bank_mask:0x3
    v_mov_b32_dpp v99, v107 row_ror:8 row_mask:0xf bank_mask:0x3
    v_perm_b32 v84, v13, v9, s9
    v_perm_b32 v104, v13, v9, s9
    v_perm_b32 v100, v15, v11, s9
    v_perm_b32 v85, v21, v17, s9
    v_perm_b32 v105, v21, v17, s9
    v_perm_b32 v101, v23, v19, s9
    v_perm_b32 v86, v29, v25, s9
    v_perm_b32 v106, v29, v25, s9
    v_perm_b32 v102, v31, v27, s9
    v_perm_b32 v87, v37, v33, s9
    v_perm_b32 v107, v37, v33, s9
    v_perm_b32 v103, v39, v35, s9
    v_mov_b32_dpp v84, v100 row_ror:8 row_mask:0xf bank_mask:0xc
    v_mov_b32_dpp v85, v101 row_ror:8 row_mask:0xf bank_mask:0xc
    v_mov_b32_dpp v86, v102 row_ror:8 row_mask:0xf bank_mask:0xc
    v_mov_b32_dpp v87, v103 row_ror:8 row_mask:0xf bank_mask:0xc
    v_mov_b32_dpp v100, v104 row_ror:8 row_mask:0xf bank_mask:0x3
    v_mov_b32_dpp v101, v105 row_ror:8 row_mask:0xf bank_mask:0x3
    v_mov_b32_dpp v102, v106 row_ror:8 row_mask:0xf bank_mask:0x3
    v_mov_b32_dpp v103, v107 row_ror:8 row_mask:0xf bank_mask:0x3
    ds_write_b128 v121, v[72:75] offset:16384
    ds_write_b128 v121, v[76:79] offset:17408
    ds_write_b128 v121, v[80:83] offset:18432
    ds_write_b128 v121, v[84:87] offset:19456
    ds_write_b128 v121, v[88:91] offset:20480
    ds_write_b128 v121, v[92:95] offset:21504
    ds_write_b128 v121, v[96:99] offset:22528
    ds_write_b128 v121, v[100:103] offset:23552
    s_setprio 2
    s_waitcnt lgkmcnt(0)
    s_mov_b32 s65, 0
poll_52:
    global_load_dword v3, v120, s[50:51] sc1
    s_waitcnt vmcnt(0)
    v_subrev_u32 v3, s63, v3
    v_subrev_u32 v3, 4, v3
    v_cmp_lt_u32 vcc, 3, v3
    s_cbranch_vccz pdone_53
    s_add_u32 s65, s65, 1
    s_cmp_lt_u32 s65, 20000
    s_sleep 1
    s_cbranch_scc1 poll_52
pdone_53:
    s_mov_b32 s15, 0
    buffer_load_dwordx4 v[72:75], v6, s[24:27], s15 offen offset:0 sc1
    buffer_load_dwordx4 v[76:79], v6, s[24:27], s15 offen offset:256 sc1
    buffer_load_dwordx4 v[80:83], v7, s[24:27], s15 offen offset:0 sc1
    buffer_load_dwordx4 v[84:87], v7, s[24:27], s15 offen offset:256 sc1
    s_mov_b32 s15, 14336
    buffer_load_dwordx4 v[88:91], v6, s[24:27], s15 offen offset:0 sc1
    buffer_load_dwordx4 v[92:95], v6, s[24:27], s15 offen offset:256 sc1
    buffer_load_dwordx4 v[96:99], v7, s[24:27], s15 offen offset:0 sc1
    buffer_load_dwordx4 v[100:103], v7, s[24:27], s15 offen offset:256 sc1
    s_mov_b32 s15, 1024
    buffer_load_dwordx4 v[104:107], v6, s[24:27], s15 offen offset:0 sc1
    buffer_load_dwordx4 v[108:111], v6, s[24:27], s15 offen offset:256 sc1
    buffer_load_dwordx4 v[112:115], v7, s[24:27], s15 offen offset:0 sc1
    buffer_load_dwordx4 v[116:119], v7, s[24:27], s15 offen offset:256 sc1
    s_waitcnt vmcnt(8)
    v_mfma_f32_16x16x32_bf16 v[8:11], v[128:131], v[72:75], 0
    v_mfma_f32_16x16x32_bf16 v[12:15], v[132:135], v[72:75], 0
    v_mfma_f32_16x16x32_bf16 v[16:19], v[136:139], v[72:75], 0
    v_mfma_f32_16x16x32_bf16 v[20:23], v[140:143], v[72:75], 0
    v_mfma_f32_16x16x32_bf16 v[24:27], v[128:131], v[76:79], 0
    v_mfma_f32_16x16x32_bf16 v[28:31], v[132:135], v[76:79], 0
    v_mfma_f32_16x16x32_bf16 v[32:35], v[136:139], v[76:79], 0
    v_mfma_f32_16x16x32_bf16 v[36:39], v[140:143], v[76:79], 0
    v_mfma_f32_16x16x32_bf16 v[40:43], v[128:131], v[80:83], 0
    v_mfma_f32_16x16x32_bf16 v[44:47], v[132:135], v[80:83], 0
    v_mfma_f32_16x16x32_bf16 v[48:51], v[136:139], v[80:83], 0
    v_mfma_f32_16x16x32_bf16 v[52:55], v[140:143], v[80:83], 0
    v_mfma_f32_16x16x32_bf16 v[56:59], v[128:131], v[84:87], 0
    v_mfma_f32_16x16x32_bf16 v[60:63], v[132:135], v[84:87], 0
    v_mfma_f32_16x16x32_bf16 v[64:67], v[136:139], v[84:87], 0
    v_mfma_f32_16x16x32_bf16 v[68:71], v[140:143], v[84:87], 0
    s_mov_b32 s15, 15360
    buffer_load_dwordx4 v[72:75], v6, s[24:27], s15 offen offset:0 sc1
    buffer_load_dwordx4 v[76:79], v6, s[24:27], s15 offen offset:256 sc1
    buffer_load_dwordx4 v[80:83], v7, s[24:27], s15 offen offset:0 sc1
    buffer_load_dwordx4 v[84:87], v7, s[24:27], s15 offen offset:256 sc1
    s_mov_b32 s15, 2048
    buffer_load_dwordx4 v[128:131], v6, s[24:27], s15 offen offset:0 sc1
    buffer_load_dwordx4 v[132:135], v6, s[24:27], s15 offen offset:256 sc1
    buffer_load_dwordx4 v[136:139], v7, s[24:27], s15 offen offset:0 sc1
    buffer_load_dwordx4 v[140:143], v7, s[24:27], s15 offen offset:256 sc1
    s_waitcnt vmcnt(12)
    v_mfma_f32_16x16x32_bf16 v[8:11], v[144:147], v[88:91], v[8:11]
    v_mfma_f32_16x16x32_bf16 v[12:15], v[148:151], v[88:91], v[12:15]
    v_mfma_f32_16x16x32_bf16 v[16:19], v[152:155], v[88:91], v[16:19]
    v_mfma_f32_16x16x32_bf16 v[20:23], v[156:159], v[88:91], v[20:23]
    v_mfma_f32_16x16x32_bf16 v[24:27], v[144:147], v[92:95], v[24:27]
    v_mfma_f32_16x16x32_bf16 v[28:31], v[148:151], v[92:95], v[28:31]
    v_mfma_f32_16x16x32_bf16 v[32:35], v[152:155], v[92:95], v[32:35]
    v_mfma_f32_16x16x32_bf16 v[36:39], v[156:159], v[92:95], v[36:39]
    v_mfma_f32_16x16x32_bf16 v[40:43], v[144:147], v[96:99], v[40:43]
    v_mfma_f32_16x16x32_bf16 v[44:47], v[148:151], v[96:99], v[44:47]
    v_mfma_f32_16x16x32_bf16 v[48:51], v[152:155], v[96:99], v[48:51]
    v_mfma_f32_16x16x32_bf16 v[52:55], v[156:159], v[96:99], v[52:55]
    v_mfma_f32_16x16x32_bf16 v[56:59], v[144:147], v[100:103], v[56:59]
    v_mfma_f32_16x16x32_bf16 v[60:63], v[148:151], v[100:103], v[60:63]
    v_mfma_f32_16x16x32_bf16 v[64:67], v[152:155], v[100:103], v[64:67]
    v_mfma_f32_16x16x32_bf16 v[68:71], v[156:159], v[100:103], v[68:71]
    s_mov_b32 s15, 16384
    buffer_load_dwordx4 v[88:91], v6, s[24:27], s15 offen offset:0 sc1
    buffer_load_dwordx4 v[92:95], v6, s[24:27], s15 offen offset:256 sc1
    buffer_load_dwordx4 v[96:99], v7, s[24:27], s15 offen offset:0 sc1
    buffer_load_dwordx4 v[100:103], v7, s[24:27], s15 offen offset:256 sc1
    s_mov_b32 s15, 3072
    buffer_load_dwordx4 v[144:147], v6, s[24:27], s15 offen offset:0 sc1
    buffer_load_dwordx4 v[148:151], v6, s[24:27], s15 offen offset:256 sc1
    buffer_load_dwordx4 v[152:155], v7, s[24:27], s15 offen offset:0 sc1
    buffer_load_dwordx4 v[156:159], v7, s[24:27], s15 offen offset:256 sc1
    s_waitcnt vmcnt(16)
    v_mfma_f32_16x16x32_bf16 v[8:11], v[160:163], v[104:107], v[8:11]
    v_mfma_f32_16x16x32_bf16 v[12:15], v[164:167], v[104:107], v[12:15]
    v_mfma_f32_16x16x32_bf16 v[16:19], v[168:171], v[104:107], v[16:19]
    v_mfma_f32_16x16x32_bf16 v[20:23], v[172:175], v[104:107], v[20:23]
    v_mfma_f32_16x16x32_bf16 v[24:27], v[160:163], v[108:111], v[24:27]
    v_mfma_f32_16x16x32_bf16 v[28:31], v[164:167], v[108:111], v[28:31]
    v_mfma_f32_16x16x32_bf16 v[32:35], v[168:171], v[108:111], v[32:35]
    v_mfma_f32_16x16x32_bf16 v[36:39], v[172:175], v[108:111], v[36:39]
    v_mfma_f32_16x16x32_bf16 v[40:43], v[160:163], v[112:115], v[40:43]
    v_mfma_f32_16x16x32_bf16 v[44:47], v[164:167], v[112:115], v[44:47]
    v_mfma_f32_16x16x32_bf16 v[48:51], v[168:171], v[112:115], v[48:51]
    v_mfma_f32_16x16x32_bf16 v[52:55], v[172:175], v[112:115], v[52:55]
    v_mfma_f32_16x16x32_bf16 v[56:59], v[160:163], v[116:119], v[56:59]
    v_mfma_f32_16x16x32_bf16 v[60:63], v[164:167], v[116:119], v[60:63]
    v_mfma_f32_16x16x32_bf16 v[64:67], v[168:171], v[116:119], v[64:67]
    v_mfma_f32_16x16x32_bf16 v[68:71], v[172:175], v[116:119], v[68:71]
    s_mov_b32 s15, 17408
    buffer_load_dwordx4 v[104:107], v6, s[24:27], s15 offen offset:0 sc1
    buffer_load_dwordx4 v[108:111], v6, s[24:27], s15 offen offset:256 sc1
    buffer_load_dwordx4 v[112:115], v7, s[24:27], s15 offen offset:0 sc1
    buffer_load_dwordx4 v[116:119], v7, s[24:27], s15 offen offset:256 sc1
    s_waitcnt vmcnt(16)
    v_mfma_f32_16x16x32_bf16 v[8:11], v[176:179], v[72:75], v[8:11]
    v_mfma_f32_16x16x32_bf16 v[12:15], v[180:183], v[72:75], v[12:15]
    v_mfma_f32_16x16x32_bf16 v[16:19], v[184:187], v[72:75], v[16:19]
    v_mfma_f32_16x16x32_bf16 v[20:23], v[188:191], v[72:75], v[20:23]
    v_mfma_f32_16x16x32_bf16 v[24:27], v[176:179], v[76:79], v[24:27]
    v_mfma_f32_16x16x32_bf16 v[28:31], v[180:183], v[76:79], v[28:31]
    v_mfma_f32_16x16x32_bf16 v[32:35], v[184:187], v[76:79], v[32:35]
    v_mfma_f32_16x16x32_bf16 v[36:39], v[188:191], v[76:79], v[36:39]
    v_mfma_f32_16x16x32_bf16 v[40:43], v[176:179], v[80:83], v[40:43]
    v_mfma_f32_16x16x32_bf16 v[44:47], v[180:183], v[80:83], v[44:47]
    v_mfma_f32_16x16x32_bf16 v[48:51], v[184:187], v[80:83], v[48:51]
    v_mfma_f32_16x16x32_bf16 v[52:55], v[188:191], v[80:83], v[52:55]
    v_mfma_f32_16x16x32_bf16 v[56:59], v[176:179], v[84:87], v[56:59]
    v_mfma_f32_16x16x32_bf16 v[60:63], v[180:183], v[84:87], v[60:63]
    v_mfma_f32_16x16x32_bf16 v[64:67], v[184:187], v[84:87], v[64:67]
    v_mfma_f32_16x16x32_bf16 v[68:71], v[188:191], v[84:87], v[68:71]
    s_waitcnt vmcnt(12)
    v_mfma_f32_16x16x32_bf16 v[8:11], v[192:195], v[128:131], v[8:11]
    v_mfma_f32_16x16x32_bf16 v[12:15], v[196:199], v[128:131], v[12:15]
    v_mfma_f32_16x16x32_bf16 v[16:19], v[200:203], v[128:131], v[16:19]
    v_mfma_f32_16x16x32_bf16 v[20:23], v[204:207], v[128:131], v[20:23]
    v_mfma_f32_16x16x32_bf16 v[24:27], v[192:195], v[132:135], v[24:27]
    v_mfma_f32_16x16x32_bf16 v[28:31], v[196:199], v[132:135], v[28:31]
    v_mfma_f32_16x16x32_bf16 v[32:35], v[200:203], v[132:135], v[32:35]
    v_mfma_f32_16x16x32_bf16 v[36:39], v[204:207], v[132:135], v[36:39]
    v_mfma_f32_16x16x32_bf16 v[40:43], v[192:195], v[136:139], v[40:43]
    v_mfma_f32_16x16x32_bf16 v[44:47], v[196:199], v[136:139], v[44:47]
    v_mfma_f32_16x16x32_bf16 v[48:51], v[200:203], v[136:139], v[48:51]
    v_mfma_f32_16x16x32_bf16 v[52:55], v[204:207], v[136:139], v[52:55]
    v_mfma_f32_16x16x32_bf16 v[56:59], v[192:195], v[140:143], v[56:59]
    v_mfma_f32_16x16x32_bf16 v[60:63], v[196:199], v[140:143], v[60:63]
    v_mfma_f32_16x16x32_bf16 v[64:67], v[200:203], v[140:143], v[64:67]
    v_mfma_f32_16x16x32_bf16 v[68:71], v[204:207], v[140:143], v[68:71]
    s_mov_b32 s65, 0
    v_mov_b32 v2, 161052
lv_55:
    ds_read_b32 v3, v2
    s_waitcnt lgkmcnt(0)
    v_cmp_eq_u32 vcc, 0, v3
    s_cbranch_vccz lvd_56
    s_add_u32 s65, s65, 1
    s_cmp_lt_u32 s65, 400000
    s_cbranch_scc1 lv_55
lvd_56:
    s_mov_b32 s15, 4096
    buffer_load_dwordx4 v[160:163], v6, s[24:27], s15 offen offset:0 sc1
    buffer_load_dwordx4 v[164:167], v6, s[24:27], s15 offen offset:256 sc1
    buffer_load_dwordx4 v[168:171], v7, s[24:27], s15 offen offset:0 sc1
    buffer_load_dwordx4 v[172:175], v7, s[24:27], s15 offen offset:256 sc1
    s_mov_b32 s15, 18432
    buffer_load_dwordx4 v[72:75], v6, s[24:27], s15 offen offset:0 sc1
    buffer_load_dwordx4 v[76:79], v6, s[24:27], s15 offen offset:256 sc1
    buffer_load_dwordx4 v[80:83], v7, s[24:27], s15 offen offset:0 sc1
    buffer_load_dwordx4 v[84:87], v7, s[24:27], s15 offen offset:256 sc1
    s_mov_b32 s15, 5120
    buffer_load_dwordx4 v[176:179], v6, s[24:27], s15 offen offset:0 sc1
    buffer_load_dwordx4 v[180:183], v6, s[24:27], s15 offen offset:256 sc1
    buffer_load_dwordx4 v[184:187], v7, s[24:27], s15 offen offset:0 sc1
    buffer_load_dwordx4 v[188:191], v7, s[24:27], s15 offen offset:256 sc1
    s_mov_b32 s15, 19456
    buffer_load_dwordx4 v[128:131], v6, s[24:27], s15 offen offset:0 sc1
    buffer_load_dwordx4 v[132:135], v6, s[24:27], s15 offen offset:256 sc1
    buffer_load_dwordx4 v[136:139], v7, s[24:27], s15 offen offset:0 sc1
    buffer_load_dwordx4 v[140:143], v7, s[24:27], s15 offen offset:256 sc1
    s_mov_b32 s15, 6144
    buffer_load_dwordx4 v[192:195], v6, s[24:27], s15 offen offset:0 sc1
    buffer_load_dwordx4 v[196:199], v6, s[24:27], s15 offen offset:256 sc1
    buffer_load_dwordx4 v[200:203], v7, s[24:27], s15 offen offset:0 sc1
    buffer_load_dwordx4 v[204:207], v7, s[24:27], s15 offen offset:256 sc1
    s_waitcnt vmcnt(28)
    v_mfma_f32_16x16x32_bf16 v[8:11], v[208:211], v[88:91], v[8:11]
    v_mfma_f32_16x16x32_bf16 v[12:15], v[212:215], v[88:91], v[12:15]
    v_mfma_f32_16x16x32_bf16 v[16:19], v[216:219], v[88:91], v[16:19]
    v_mfma_f32_16x16x32_bf16 v[20:23], v[220:223], v[88:91], v[20:23]
    v_mfma_f32_16x16x32_bf16 v[24:27], v[208:211], v[92:95], v[24:27]
    v_mfma_f32_16x16x32_bf16 v[28:31], v[212:215], v[92:95], v[28:31]
    v_mfma_f32_16x16x32_bf16 v[32:35], v[216:219], v[92:95], v[32:35]
    v_mfma_f32_16x16x32_bf16 v[36:39], v[220:223], v[92:95], v[36:39]
    v_mfma_f32_16x16x32_bf16 v[40:43], v[208:211], v[96:99], v[40:43]
    v_mfma_f32_16x16x32_bf16 v[44:47], v[212:215], v[96:99], v[44:47]
    v_mfma_f32_16x16x32_bf16 v[48:51], v[216:219], v[96:99], v[48:51]
    v_mfma_f32_16x16x32_bf16 v[52:55], v[220:223], v[96:99], v[52:55]
    v_mfma_f32_16x16x32_bf16 v[56:59], v[208:211], v[100:103], v[56:59]
    v_mfma_f32_16x16x32_bf16 v[60:63], v[212:215], v[100:103], v[60:63]
    v_mfma_f32_16x16x32_bf16 v[64:67], v[216:219], v[100:103], v[64:67]
    v_mfma_f32_16x16x32_bf16 v[68:71], v[220:223], v[100:103], v[68:71]
    s_mov_b32 s15, 20480
    buffer_load_dwordx4 v[88:91], v6, s[24:27], s15 offen offset:0 sc1
    buffer_load_dwordx4 v[92:95], v6, s[24:27], s15 offen offset:256 sc1
    buffer_load_dwordx4 v[96:99], v7, s[24:27], s15 offen offset:0 sc1
    buffer_load_dwordx4 v[100:103], v7, s[24:27], s15 offen offset:256 sc1
    s_waitcnt vmcnt(28)
    v_mfma_f32_16x16x32_bf16 v[8:11], v[224:227], v[144:147], v[8:11]
    v_mfma_f32_16x16x32_bf16 v[12:15], v[228:231], v[144:147], v[12:15]
    v_mfma_f32_16x16x32_bf16 v[16:19], v[232:235], v[144:147], v[16:19]
    v_mfma_f32_16x16x32_bf16 v[20:23], v[236:239], v[144:147], v[20:23]
    v_mfma_f32_16x16x32_bf16 v[24:27], v[224:227], v[148:151], v[24:27]
    v_mfma_f32_16x16x32_bf16 v[28:31], v[228:231], v[148:151], v[28:31]
    v_mfma_f32_16x16x32_bf16 v[32:35], v[232:235], v[148:151], v[32:35]
    v_mfma_f32_16x16x32_bf16 v[36:39], v[236:239], v[148:151], v[36:39]
    v_mfma_f32_16x16x32_bf16 v[40:43], v[224:227], v[152:155], v[40:43]
    v_mfma_f32_16x16x32_bf16 v[44:47], v[228:231], v[152:155], v[44:47]
    v_mfma_f32_16x16x32_bf16 v[48:51], v[232:235], v[152:155], v[48:51]
    v_mfma_f32_16x16x32_bf16 v[52:55], v[236:239], v[152:155], v[52:55]
    v_mfma_f32_16x16x32_bf16 v[56:59], v[224:227], v[156:159], v[56:59]
    v_mfma_f32_16x16x32_bf16 v[60:63], v[228:231], v[156:159], v[60:63]
    v_mfma_f32_16x16x32_bf16 v[64:67], v[232:235], v[156:159], v[64:67]
    v_mfma_f32_16x16x32_bf16 v[68:71], v[236:239], v[156:159], v[68:71]
    ds_read_b128 v[208:211], v121 offset:0
    ds_read_b128 v[212:215], v121 offset:1024
    ds_read_b128 v[216:219], v121 offset:2048
    ds_read_b128 v[220:223], v121 offset:3072
    ds_read_b128 v[144:147], v121 offset:4096
    ds_read_b128 v[148:151], v121 offset:5120
    ds_read_b128 v[152:155], v121 offset:6144
    ds_read_b128 v[156:159], v121 offset:7168
    v_bfe_u32 v2, v1, 4, 1
    v_lshlrev_b32 v2, 17, v2
    v_lshrrev_b32 v3, 5, v1
    v_lshl_add_u32 v2, v3, 14, v2
    v_and_b32 v3, 15, v1
    v_lshl_add_u32 v2, v3, 2, v2
    s_lshl_b32 s15, s19, 18
    s_lshl_b32 s3, s64, 6
    s_add_u32 s15, s15, s3
    s_lshl_b32 s3, s18, 8
    s_add_u32 s15, s15, s3
    v_add_u32 v2, s15, v2
    s_mov_b32 s15, 0
    buffer_load_dword v224, v2, s[36:39], s15 offen sc1
    s_mov_b32 s15, 8192
    buffer_load_dword v225, v2, s[36:39], s15 offen sc1
    s_mov_b32 s15, 32768
    buffer_load_dword v226, v2, s[36:39], s15 offen sc1
    s_mov_b32 s15, 40960
    buffer_load_dword v227, v2, s[36:39], s15 offen sc1
    s_mov_b32 s15, 65536
    buffer_load_dword v228, v2, s[36:39], s15 offen sc1
    s_mov_b32 s15, 73728
    buffer_load_dword v229, v2, s[36:39], s15 offen sc1
    s_mov_b32 s15, 98304
    buffer_load_dword v230, v2, s[36:39], s15 offen sc1
    s_mov_b32 s15, 106496
    buffer_load_dword v231, v2, s[36:39], s15 offen sc1
    s_waitcnt vmcnt(32)
    v_mfma_f32_16x16x32_bf16 v[8:11], v[240:243], v[104:107], v[8:11]
    v_mfma_f32_16x16x32_bf16 v[12:15], v[244:247], v[104:107], v[12:15]
    v_mfma_f32_16x16x32_bf16 v[16:19], v[248:251], v[104:107], v[16:19]
    v_mfma_f32_16x16x32_bf16 v[20:23], v[252:255], v[104:107], v[20:23]
    v_mfma_f32_16x16x32_bf16 v[24:27], v[240:243], v[108:111], v[24:27]
    v_mfma_f32_16x16x32_bf16 v[28:31], v[244:247], v[108:111], v[28:31]
    v_mfma_f32_16x16x32_bf16 v[32:35], v[248:251], v[108:111], v[32:35]
    v_mfma_f32_16x16x32_bf16 v[36:39], v[252:255], v[108:111], v[36:39]
    v_mfma_f32_16x16x32_bf16 v[40:43], v[240:243], v[112:115], v[40:43]
    v_mfma_f32_16x16x32_bf16 v[44:47], v[244:247], v[112:115], v[44:47]
    v_mfma_f32_16x16x32_bf16 v[48:51], v[248:251], v[112:115], v[48:51]
    v_mfma_f32_16x16x32_bf16 v[52:55], v[252:255], v[112:115], v[52:55]
    v_mfma_f32_16x16x32_bf16 v[56:59], v[240:243], v[116:119], v[56:59]
    v_mfma_f32_16x16x32_bf16 v[60:63], v[244:247], v[116:119], v[60:63]
    v_mfma_f32_16x16x32_bf16 v[64:67], v[248:251], v[116:119], v[64:67]
    v_mfma_f32_16x16x32_bf16 v[68:71], v[252:255], v[116:119], v[68:71]
    s_waitcnt vmcnt(28) lgkmcnt(4)
    v_mfma_f32_16x16x32_bf16 v[8:11], v[208:211], v[160:163], v[8:11]
    v_mfma_f32_16x16x32_bf16 v[12:15], v[212:215], v[160:163], v[12:15]
    v_mfma_f32_16x16x32_bf16 v[16:19], v[216:219], v[160:163], v[16:19]
    v_mfma_f32_16x16x32_bf16 v[20:23], v[220:223], v[160:163], v[20:23]
    v_mfma_f32_16x16x32_bf16 v[24:27], v[208:211], v[164:167], v[24:27]
    v_mfma_f32_16x16x32_bf16 v[28:31], v[212:215], v[164:167], v[28:31]
    v_mfma_f32_16x16x32_bf16 v[32:35], v[216:219], v[164:167], v[32:35]
    v_mfma_f32_16x16x32_bf16 v[36:39], v[220:223], v[164:167], v[36:39]
    v_mfma_f32_16x16x32_bf16 v[40:43], v[208:211], v[168:171], v[40:43]
    v_mfma_f32_16x16x32_bf16 v[44:47], v[212:215], v[168:171], v[44:47]
    v_mfma_f32_16x16x32_bf16 v[48:51], v[216:219], v[168:171], v[48:51]
    v_mfma_f32_16x16x32_bf16 v[52:55], v[220:223], v[168:171], v[52:55]
    v_mfma_f32_16x16x32_bf16 v[56:59], v[208:211], v[172:175], v[56:59]
    v_mfma_f32_16x16x32_bf16 v[60:63], v[212:215], v[172:175], v[60:63]
    v_mfma_f32_16x16x32_bf16 v[64:67], v[216:219], v[172:175], v[64:67]
    v_mfma_f32_16x16x32_bf16 v[68:71], v[220:223], v[172:175], v[68:71]
    ds_read_b128 v[208:211], v121 offset:8192
    ds_read_b128 v[212:215], v121 offset:9216
    ds_read_b128 v[216:219], v121 offset:10240
    ds_read_b128 v[220:223], v121 offset:11264
    s_waitcnt vmcnt(24) lgkmcnt(4)
    v_mfma_f32_16x16x32_bf16 v[8:11], v[144:147], v[72:75], v[8:11]
    v_mfma_f32_16x16x32_bf16 v[12:15], v[148:151], v[72:75], v[12:15]
    v_mfma_f32_16x16x32_bf16 v[16:19], v[152:155], v[72:75], v[16:19]
    v_mfma_f32_16x16x32_bf16 v[20:23], v[156:159], v[72:75], v[20:23]
    v_mfma_f32_16x16x32_bf16 v[24:27], v[144:147], v[76:79], v[24:27]
    v_mfma_f32_16x16x32_bf16 v[28:31], v[148:151], v[76:79], v[28:31]
    v_mfma_f32_16x16x32_bf16 v[32:35], v[152:155], v[76:79], v[32:35]
    v_mfma_f32_16x16x32_bf16 v[36:39], v[156:159], v[76:79], v[36:39]
    v_mfma_f32_16x16x32_bf16 v[40:43], v[144:147], v[80:83], v[40:43]
    v_mfma_f32_16x16x32_bf16 v[44:47], v[148:151], v[80:83], v[44:47]
    v_mfma_f32_16x16x32_bf16 v[48:51], v[152:155], v[80:83], v[48:51]
    v_mfma_f32_16x16x32_bf16 v[52:55], v[156:159], v[80:83], v[52:55]
    v_mfma_f32_16x16x32_bf16 v[56:59], v[144:147], v[84:87], v[56:59]
    v_mfma_f32_16x16x32_bf16 v[60:63], v[148:151], v[84:87], v[60:63]
    v_mfma_f32_16x16x32_bf16 v[64:67], v[152:155], v[84:87], v[64:67]
    v_mfma_f32_16x16x32_bf16 v[68:71], v[156:159], v[84:87], v[68:71]
    ds_read_b128 v[144:147], v121 offset:12288
    ds_read_b128 v[148:151], v121 offset:13312
    ds_read_b128 v[152:155], v121 offset:14336
    ds_read_b128 v[156:159], v121 offset:15360
    s_waitcnt vmcnt(20) lgkmcnt(4)
    v_mfma_f32_16x16x32_bf16 v[8:11], v[208:211], v[176:179], v[8:11]
    v_mfma_f32_16x16x32_bf16 v[12:15], v[212:215], v[176:179], v[12:15]
    v_mfma_f32_16x16x32_bf16 v[16:19], v[216:219], v[176:179], v[16:19]
    v_mfma_f32_16x16x32_bf16 v[20:23], v[220:223], v[176:179], v[20:23]
    v_mfma_f32_16x16x32_bf16 v[24:27], v[208:211], v[180:183], v[24:27]
    v_mfma_f32_16x16x32_bf16 v[28:31], v[212:215], v[180:183], v[28:31]
    v_mfma_f32_16x16x32_bf16 v[32:35], v[216:219], v[180:183], v[32:35]
    v_mfma_f32_16x16x32_bf16 v[36:39], v[220:223], v[180:183], v[36:39]
    v_mfma_f32_16x16x32_bf16 v[40:43], v[208:211], v[184:187], v[40:43]
    v_mfma_f32_16x16x32_bf16 v[44:47], v[212:215], v[184:187], v[44:47]
    v_mfma_f32_16x16x32_bf16 v[48:51], v[216:219], v[184:187], v[48:51]
    v_mfma_f32_16x16x32_bf16 v[52:55], v[220:223], v[184:187], v[52:55]
    v_mfma_f32_16x16x32_bf16 v[56:59], v[208:211], v[188:191], v[56:59]
    v_mfma_f32_16x16x32_bf16 v[60:63], v[212:215], v[188:191], v[60:63]
    v_mfma_f32_16x16x32_bf16 v[64:67], v[216:219], v[188:191], v[64:67]
    v_mfma_f32_16x16x32_bf16 v[68:71], v[220:223], v[188:191], v[68:71]
    ds_read_b128 v[208:211], v121 offset:16384
    ds_read_b128 v[212:215], v121 offset:17408
    ds_read_b128 v[216:219], v121 offset:18432
    ds_read_b128 v[220:223], v121 offset:19456
    s_waitcnt vmcnt(16) lgkmcnt(4)
    v_mfma_f32_16x16x32_bf16 v[8:11], v[144:147], v[128:131], v[8:11]
    v_mfma_f32_16x16x32_bf16 v[12:15], v[148:151], v[128:131], v[12:15]
    v_mfma_f32_16x16x32_bf16 v[16:19], v[152:155], v[128:131], v[16:19]
    v_mfma_f32_16x16x32_bf16 v[20:23], v[156:159], v[128:131], v[20:23]
    v_mfma_f32_16x16x32_bf16 v[24:27], v[144:147], v[132:135], v[24:27]
    v_mfma_f32_16x16x32_bf16 v[28:31], v[148:151], v[132:135], v[28:31]
    v_mfma_f32_16x16x32_bf16 v[32:35], v[152:155], v[132:135], v[32:35]
    v_mfma_f32_16x16x32_bf16 v[36:39], v[156:159], v[132:135], v[36:39]
    v_mfma_f32_16x16x32_bf16 v[40:43], v[144:147], v[136:139], v[40:43]
    v_mfma_f32_16x16x32_bf16 v[44:47], v[148:151], v[136:139], v[44:47]
    v_mfma_f32_16x16x32_bf16 v[48:51], v[152:155], v[136:139], v[48:51]
    v_mfma_f32_16x16x32_bf16 v[52:55], v[156:159], v[136:139], v[52:55]
    v_mfma_f32_16x16x32_bf16 v[56:59], v[144:147], v[140:143], v[56:59]
    v_mfma_f32_16x16x32_bf16 v[60:63], v[148:151], v[140:143], v[60:63]
    v_mfma_f32_16x16x32_bf16 v[64:67], v[152:155], v[140:143], v[64:67]
    v_mfma_f32_16x16x32_bf16 v[68:71], v[156:159], v[140:143], v[68:71]
    ds_read_b128 v[144:147], v121 offset:20480
    ds_read_b128 v[148:151], v121 offset:21504
    ds_read_b128 v[152:155], v121 offset:22528
    ds_read_b128 v[156:159], v121 offset:23552
    s_waitcnt vmcnt(12) lgkmcnt(4)
    v_mfma_f32_16x16x32_bf16 v[8:11], v[208:211], v[192:195], v[8:11]
    v_mfma_f32_16x16x32_bf16 v[12:15], v[212:215], v[192:195], v[12:15]
    v_mfma_f32_16x16x32_bf16 v[16:19], v[216:219], v[192:195], v[16:19]
    v_mfma_f32_16x16x32_bf16 v[20:23], v[220:223], v[192:195], v[20:23]
    v_mfma_f32_16x16x32_bf16 v[24:27], v[208:211], v[196:199], v[24:27]
    v_mfma_f32_16x16x32_bf16 v[28:31], v[212:215], v[196:199], v[28:31]
    v_mfma_f32_16x16x32_bf16 v[32:35], v[216:219], v[196:199], v[32:35]
    v_mfma_f32_16x16x32_bf16 v[36:39], v[220:223], v[196:199], v[36:39]
    v_mfma_f32_16x16x32_bf16 v[40:43], v[208:211], v[200:203], v[40:43]
    v_mfma_f32_16x16x32_bf16 v[44:47], v[212:215], v[200:203], v[44:47]
    v_mfma_f32_16x16x32_bf16 v[48:51], v[216:219], v[200:203], v[48:51]
    v_mfma_f32_16x16x32_bf16 v[52:55], v[220:223], v[200:203], v[52:55]
    v_mfma_f32_16x16x32_bf16 v[56:59], v[208:211], v[204:207], v[56:59]
    v_mfma_f32_16x16x32_bf16 v[60:63], v[212:215], v[204:207], v[60:63]
    v_mfma_f32_16x16x32_bf16 v[64:67], v[216:219], v[204:207], v[64:67]
    v_mfma_f32_16x16x32_bf16 v[68:71], v[220:223], v[204:207], v[68:71]
    s_waitcnt vmcnt(8) lgkmcnt(0)
    v_mfma_f32_16x16x32_bf16 v[8:11], v[144:147], v[88:91], v[8:11]
    v_mfma_f32_16x16x32_bf16 v[12:15], v[148:151], v[88:91], v[12:15]
    v_mfma_f32_16x16x32_bf16 v[16:19], v[152:155], v[88:91], v[16:19]
    v_mfma_f32_16x16x32_bf16 v[20:23], v[156:159], v[88:91], v[20:23]
    v_mfma_f32_16x16x32_bf16 v[24:27], v[144:147], v[92:95], v[24:27]
    v_mfma_f32_16x16x32_bf16 v[28:31], v[148:151], v[92:95], v[28:31]
    v_mfma_f32_16x16x32_bf16 v[32:35], v[152:155], v[92:95], v[32:35]
    v_mfma_f32_16x16x32_bf16 v[36:39], v[156:159], v[92:95], v[36:39]
    v_mfma_f32_16x16x32_bf16 v[40:43], v[144:147], v[96:99], v[40:43]
    v_mfma_f32_16x16x32_bf16 v[44:47], v[148:151], v[96:99], v[44:47]
    v_mfma_f32_16x16x32_bf16 v[48:51], v[152:155], v[96:99], v[48:51]
    v_mfma_f32_16x16x32_bf16 v[52:55], v[156:159], v[96:99], v[52:55]
    v_mfma_f32_16x16x32_bf16 v[56:59], v[144:147], v[100:103], v[56:59]
    v_mfma_f32_16x16x32_bf16 v[60:63], v[148:151], v[100:103], v[60:63]
    v_mfma_f32_16x16x32_bf16 v[64:67], v[152:155], v[100:103], v[64:67]
    v_mfma_f32_16x16x32_bf16 v[68:71], v[156:159], v[100:103], v[68:71]
    ds_write_b128 v121, v[8:11] offset:0
    ds_write_b128 v121, v[12:15] offset:1024
    ds_write_b128 v121, v[16:19] offset:2048
    ds_write_b128 v121, v[20:23] offset:3072
    ds_write_b128 v121, v[24:27] offset:4096
    ds_write_b128 v121, v[28:31] offset:5120
    ds_write_b128 v121, v[32:35] offset:6144
    ds_write_b128 v121, v[36:39] offset:7168
    ds_write_b128 v121, v[40:43] offset:8192
    ds_write_b128 v121, v[44:47] offset:9216
    ds_write_b128 v121, v[48:51] offset:10240
    ds_write_b128 v121, v[52:55] offset:11264
    ds_write_b128 v121, v[56:59] offset:12288
    ds_write_b128 v121, v[60:63] offset:13312
    ds_write_b128 v121, v[64:67] offset:14336
    ds_write_b128 v121, v[68:71] offset:15360
    s_lshl_b32 s3, s64, 2
    s_add_u32 s3, s3, 160816
    v_mov_b32 v4, s3
    v_mov_b32 v5, 1
    ds_write_b32 v4, v5
    v_bfe_u32 v2, v1, 4, 1
    v_lshlrev_b32 v2, 3, v2
    v_lshrrev_b32 v4, 5, v1
    v_add_u32 v2, v2, v4
    v_lshlrev_b32 v4, 4, v2
    v_add_u32 v4, 159744, v4
    ds_read_b128 v[104:107], v4 offset:0
    ds_read_b128 v[108:111], v4 offset:32
    ds_read_b128 v[112:115], v4 offset:64
    ds_read_b128 v[116:119], v4 offset:96
    v_and_b32 v3, 15, v1
    s_lshl_b32 s3, s64, 4
    s_lshl_b32 s15, s18, 6
    s_add_u32 s15, s15, s3
    v_add_u32 v3, s15, v3
    v_mul_u32_u24 v3, 896, v3
    v_lshl_add_u32 v3, v2, 3, v3
    s_lshl_b32 s15, s19, 7
    v_add_u32 v3, s15, v3
    s_lshl_b32 s15, s64, 12
    v_lshl_add_u32 v4, v1, 4, s15
    v_add_u32 v2, 66816, v4
    s_waitcnt vmcnt(0)
    v_lshlrev_b32 v160, 16, v224
    v_and_b32 v161, 0xffff0000, v224
    v_lshlrev_b32 v162, 16, v225
    v_and_b32 v163, 0xffff0000, v225
    v_lshlrev_b32 v164, 16, v226
    v_and_b32 v165, 0xffff0000, v226
    v_lshlrev_b32 v166, 16, v227
    v_and_b32 v167, 0xffff0000, v227
    v_lshlrev_b32 v168, 16, v228
    v_and_b32 v169, 0xffff0000, v228
    v_lshlrev_b32 v170, 16, v229
    v_and_b32 v171, 0xffff0000, v229
    v_lshlrev_b32 v172, 16, v230
    v_and_b32 v173, 0xffff0000, v230
    v_lshlrev_b32 v174, 16, v231
    v_and_b32 v175, 0xffff0000, v231
    s_mov_b32 s65, 0
    v_mov_b32 v5, 160816
lf_57:
    ds_read_b128 v[240:243], v5
    s_waitcnt lgkmcnt(0)
    v_and_b32 v240, v240, v241
    v_and_b32 v242, v242, v243
    v_and_b32 v240, v240, v242
    v_cmp_eq_u32 vcc, 0, v240
    s_cbranch_vccz lfd_58
    s_add_u32 s65, s65, 1
    s_cmp_lt_u32 s65, 400000
    s_cbranch_scc1 lf_57
lfd_58:
    ds_read_b128 v[8:11], v4 offset:0
    ds_read_b128 v[12:15], v4 offset:1024
    ds_read_b128 v[16:19], v4 offset:2048
    ds_read_b128 v[20:23], v4 offset:3072
    ds_read_b128 v[24:27], v2 offset:58368
    ds_read_b128 v[28:31], v2 offset:59392
    ds_read_b128 v[32:35], v2 offset:60416
    ds_read_b128 v[36:39], v2 offset:61440
    ds_read_b128 v[40:43], v4 offset:29184
    ds_read_b128 v[44:47], v4 offset:30208
    ds_read_b128 v[48:51], v4 offset:31232
    ds_read_b128 v[52:55], v4 offset:32256
    ds_read_b128 v[56:59], v2 offset:0
    ds_read_b128 v[60:63], v2 offset:1024
    ds_read_b128 v[64:67], v2 offset:2048
    ds_read_b128 v[68:71], v2 offset:3072
    s_waitcnt lgkmcnt(8)
    v_pk_add_f32 v[8:9], v[8:9], v[24:25]
    v_pk_add_f32 v[10:11], v[10:11], v[26:27]
    v_pk_add_f32 v[12:13], v[12:13], v[28:29]
    v_pk_add_f32 v[14:15], v[14:15], v[30:31]
    v_pk_add_f32 v[16:17], v[16:17], v[32:33]
    v_pk_add_f32 v[18:19], v[18:19], v[34:35]
    v_pk_add_f32 v[20:21], v[20:21], v[36:37]
    v_pk_add_f32 v[22:23], v[22:23], v[38:39]
    s_waitcnt lgkmcnt(0)
    v_pk_add_f32 v[40:41], v[40:41], v[56:57]
    v_pk_add_f32 v[42:43], v[42:43], v[58:59]
    v_pk_add_f32 v[44:45], v[44:45], v[60:61]
    v_pk_add_f32 v[46:47], v[46:47], v[62:63]
    v_pk_add_f32 v[48:49], v[48:49], v[64:65]
    v_pk_add_f32 v[50:51], v[50:51], v[66:67]
    v_pk_add_f32 v[52:53], v[52:53], v[68:69]
    v_pk_add_f32 v[54:55], v[54:55], v[70:71]
    v_pk_add_f32 v[8:9], v[8:9], v[40:41]
    v_pk_add_f32 v[10:11], v[10:11], v[42:43]
    v_pk_add_f32 v[12:13], v[12:13], v[44:45]
    v_pk_add_f32 v[14:15], v[14:15], v[46:47]
    v_pk_add_f32 v[16:17], v[16:17], v[48:49]
    v_pk_add_f32 v[18:19], v[18:19], v[50:51]
    v_pk_add_f32 v[20:21], v[20:21], v[52:53]
    v_pk_add_f32 v[22:23], v[22:23], v[54:55]
    v_fmac_f32 v160, v104, v8
    v_fmac_f32 v161, v105, v12
    v_fmac_f32 v162, v106, v16
    v_fmac_f32 v163, v107, v20
    v_fmac_f32 v164, v108, v9
    v_fmac_f32 v165, v109, v13
    v_fmac_f32 v166, v110, v17
    v_fmac_f32 v167, v111, v21
    v_fmac_f32 v168, v112, v10
    v_fmac_f32 v169, v113, v14
    v_fmac_f32 v170, v114, v18
    v_fmac_f32 v171, v115, v22
    v_fmac_f32 v172, v116, v11
    v_fmac_f32 v173, v117, v15
    v_fmac_f32 v174, v118, v19
    v_fmac_f32 v175, v119, v23
    v_cvt_pk_bf16_f32 v40, v160, v161
    v_cvt_pk_bf16_f32 v41, v162, v163
    v_cvt_pk_bf16_f32 v42, v164, v165
    v_cvt_pk_bf16_f32 v43, v166, v167
    v_cvt_pk_bf16_f32 v44, v168, v169
    v_cvt_pk_bf16_f32 v45, v170, v171
    v_cvt_pk_bf16_f32 v46, v172, v173
    v_cvt_pk_bf16_f32 v47, v174, v175
    global_store_dwordx2 v3, v[40:41], s[46:47] offset:0
    global_store_dwordx2 v3, v[42:43], s[46:47] offset:16
    global_store_dwordx2 v3, v[44:45], s[46:47] offset:32
    global_store_dwordx2 v3, v[46:47], s[46:47] offset:48
    s_cmp_eq_u32 s2, 0
    s_cbranch_scc0 L_fin
    s_cmp_eq_u32 s6, 4
    s_cbranch_scc0 L_fin
    v_mov_b32 v2, 0
    v_mov_b32 v4, s7
    s_mov_b64 exec, 1
    global_store_dword v2, v4, s[50:51] sc1
    s_mov_b64 exec, -1
L_fin:
L_end:
    s_endpgm
L_code_end:
.section .rodata,"a"
.p2align 6
.amdhsa_kernel adaLN_cond__ssm_conv_s4__glu_gated_bilinear__prompt_kernel
  .amdhsa_next_free_vgpr 256
  .amdhsa_next_free_sgpr 102
  .amdhsa_accum_offset 256
  .amdhsa_group_segment_fixed_size 0
  .amdhsa_kernarg_size 144
  .amdhsa_user_sgpr_count 2
  .amdhsa_user_sgpr_kernarg_segment_ptr 1
  .amdhsa_system_sgpr_workgroup_id_x 1
.end_amdhsa_kernel
```
